```python
import torch

def _softmax(x, axis=-1):
    return torch.softmax(x, dim=axis)
def _gelu(x):
    return torch.nn.functional.gelu(x, approximate="tanh")
def _silu(x):
    return torch.nn.functional.silu(x)
def _sigmoid(x):
    return torch.sigmoid(x)
def _layernorm(x, axis=-1, eps=1e-5):
    m = x.mean(dim=axis, keepdim=True)
    v = x.var(dim=axis, keepdim=True, unbiased=False)
    return (x - m) / torch.sqrt(v + eps)
def _scatter_add(tgt, idx, src, axis=0):
    return tgt.clone().index_add_(axis, idx, src)
def _segment_sum(src, seg, n):
    out = torch.zeros((n,) + src.shape[1:], dtype=src.dtype)
    return out.index_add_(0, seg, src)
def _pad(x, pw):
    flat = tuple(v for pair in reversed(pw) for v in pair)
    return torch.nn.functional.pad(x, flat)

kernel_name = 'parallel_sum__gqa_block_cached__dense_activation_squared_relu__decode'

def setup_inputs():

    _w = (lambda a: (lambda t: t.to(torch.bfloat16) if t.is_floating_point() else t)(torch.as_tensor(a)))
    def _A_setup():
        B, Sq, D = 4, 1, 640
        Hq, Hkv, Sk, Dh = 32, 32, 8192, 128
        assert Hq % Hkv == 0, (Hq, Hkv)
        return {
            "x": _w((lambda *s: torch.randn(*s, dtype=torch.bfloat16) * 0.05)(B, Sq, D)),
            "k_cache": _w((lambda *s: torch.randn(*s, dtype=torch.bfloat16) * 1.6)(B, Hkv, Sk, Dh)),
            "v_cache": _w((lambda *s: torch.randn(*s, dtype=torch.bfloat16) * 3.2)(B, Hkv, Sk, Dh)),
            "wq": _w((lambda *s: torch.randn(*s, dtype=torch.bfloat16) * 1.6)(D, Hq * Dh) * (D ** -0.5)),
            "wo": _w((lambda *s: torch.randn(*s, dtype=torch.bfloat16) * 3.2)(Hq * Dh, D) * ((Hq * Dh) ** -0.5)),
        }
    _A_in = _A_setup()

    def _B_setup():
        B, S, D, F = 4, 1, 640, 1728
        return {
            "x": _w((lambda *s: torch.randn(*s, dtype=torch.bfloat16) * 0.05)(B, S, D)),
            "w1": _w((lambda *s: torch.randn(*s, dtype=torch.bfloat16) * 0.05)(D, F)),
            "b1": _w((lambda *s: torch.randn(*s, dtype=torch.bfloat16) * 0.4)(F)),
            "w2": _w((lambda *s: torch.randn(*s, dtype=torch.bfloat16) * 0.05)(F, D)),
            "b2": _w((lambda *s: torch.randn(*s, dtype=torch.bfloat16) * 1.6)(D)),
        }
    _B_in = _B_setup()

    return {
        "A_x": _A_in["x"],
        "A_k_cache": _A_in["k_cache"],
        "A_v_cache": _A_in["v_cache"],
        "A_wq": _A_in["wq"],
        "A_wo": _A_in["wo"],
        "B_x": _B_in["x"],
        "B_w1": _B_in["w1"],
        "B_b1": _B_in["b1"],
        "B_w2": _B_in["w2"],
        "B_b2": _B_in["b2"],
    }

def reference(A_x, A_k_cache, A_v_cache, A_wq, A_wo, B_x, B_w1, B_b1, B_w2, B_b2):
    def _A_ref(x, k_cache, v_cache, wq, wo):
        B, Sq, D = x.shape
        Hq, Dh = 32, 128
        Hkv = k_cache.shape[1]
        rep = Hq // Hkv
        q = (lambda x, *d: x.permute(*d))((x @ wq).reshape(B, Sq, Hq, Dh), 0, 2, 1, 3)
        k = (lambda x, n, axis: torch.repeat_interleave(x, n, dim=axis))(k_cache, rep, axis=1)
        v = (lambda x, n, axis: torch.repeat_interleave(x, n, dim=axis))(v_cache, rep, axis=1)
        scores = torch.einsum("bhqd,bhkd->bhqk", q, k) * (Dh ** -0.5)
        p = _softmax(scores, axis=-1)
        o = torch.einsum("bhqk,bhkd->bhqd", p, v)
        return (lambda x, *d: x.permute(*d))(o, 0, 2, 1, 3).reshape(B, Sq, Hq * Dh) @ wo

    def _B_ref(x, w1, b1, w2, b2):
        h = torch.einsum("bsd,df->bsf", x, w1) + b1
        zero = torch.zeros_like(h)
        r = torch.where(h > zero, h, zero)
        h = r * r
        out = torch.einsum("bsf,fd->bsd", h, w2) + b2
        return out

    x = A_x
    xn = _layernorm(x, axis=-1)
    return x + _A_ref(xn, A_k_cache, A_v_cache, A_wq, A_wo) + _B_ref(xn, B_w1, B_b1, B_w2, B_b2)
```

```asm
; @launch grid=(256,1,1) block=(512,1,1) lds=153600
.amdgcn_target "amdgcn-amd-amdhsa--gfx950"
.text
.globl parallel_sum__gqa_block_cached__dense_activation_squared_relu__decode_kernel
.p2align 8
.type parallel_sum__gqa_block_cached__dense_activation_squared_relu__decode_kernel,@function
parallel_sum__gqa_block_cached__dense_activation_squared_relu__decode_kernel:
  s_cmp_ge_u32 s2, 256
  s_cbranch_scc1 L_end
  s_load_dwordx16 s[16:31], s[0:1], 0
  s_load_dwordx8 s[32:39], s[0:1], 64
  s_load_dwordx2 s[40:41], s[0:1], 96
  v_lshrrev_b32 v2, 6, v0
  v_and_b32 v1, 63, v0
  v_readfirstlane_b32 s42, v2
  s_lshr_b32 s43, s2, 3
  s_and_b32 s44, s2, 7
  s_mov_b32 s46, 0xffff0000
  s_mov_b32 s47, 0x3fb8aa3b
  s_mov_b32 s82, 0x3db504f3
  s_mov_b32 s83, 262144
  v_lshlrev_b32 v3, 2, v1
  v_mov_b32 v4, 0
  s_cmp_eq_u32 s42, 4
  s_cbranch_scc0 L_nosyinit
  ds_write_b32 v3, v4 offset:20992
L_nosyinit:
  s_waitcnt lgkmcnt(0)
  s_barrier
  s_cmp_lt_u32 s42, 4
  s_cbranch_scc1 L_swave
  s_setprio 3
  s_sub_u32 s45, s42, 4
  v_lshlrev_b32 v2, 4, v1
  s_mul_i32 s76, s45, 1280
  v_add_u32 v4, s76, v2
  v_add_u32 v5, s76, v3
  global_load_dwordx4 v[8:11], v4, s[16:17]
  global_load_dword v12, v5, s[16:17] offset:1024
  s_mul_i32 s77, s44, 80
  s_mul_i32 s78, s45, 20
  s_add_u32 s64, s77, s78
  s_lshl_b32 s69, s64, 13
  s_lshl_b32 s78, s43, 8
  s_add_u32 s69, s69, s78
  s_mov_b32 s56, s22
  s_mov_b32 s57, s23
  s_mov_b32 s58, 5242880
  s_mov_b32 s59, 0x20000
  buffer_load_dword v32, v3, s[56:59], s69 offen nt
  s_add_u32 s69, s69, 8192
  buffer_load_dword v33, v3, s[56:59], s69 offen nt
  s_add_u32 s69, s69, 8192
  buffer_load_dword v34, v3, s[56:59], s69 offen nt
  s_add_u32 s69, s69, 8192
  buffer_load_dword v35, v3, s[56:59], s69 offen nt
  s_add_u32 s69, s69, 8192
  buffer_load_dword v36, v3, s[56:59], s69 offen nt
  s_add_u32 s69, s69, 8192
  buffer_load_dword v37, v3, s[56:59], s69 offen nt
  s_add_u32 s69, s69, 8192
  buffer_load_dword v38, v3, s[56:59], s69 offen nt
  s_add_u32 s69, s69, 8192
  buffer_load_dword v39, v3, s[56:59], s69 offen nt
  s_add_u32 s69, s69, 8192
  buffer_load_dword v40, v3, s[56:59], s69 offen nt
  s_add_u32 s69, s69, 8192
  buffer_load_dword v41, v3, s[56:59], s69 offen nt
  s_add_u32 s69, s69, 8192
  buffer_load_dword v42, v3, s[56:59], s69 offen nt
  s_add_u32 s69, s69, 8192
  buffer_load_dword v43, v3, s[56:59], s69 offen nt
  s_add_u32 s69, s69, 8192
  buffer_load_dword v44, v3, s[56:59], s69 offen nt
  s_add_u32 s69, s69, 8192
  buffer_load_dword v45, v3, s[56:59], s69 offen nt
  s_add_u32 s69, s69, 8192
  buffer_load_dword v46, v3, s[56:59], s69 offen nt
  s_add_u32 s69, s69, 8192
  buffer_load_dword v47, v3, s[56:59], s69 offen nt
  s_add_u32 s69, s69, 8192
  buffer_load_dword v48, v3, s[56:59], s69 offen nt
  s_add_u32 s69, s69, 8192
  buffer_load_dword v49, v3, s[56:59], s69 offen nt
  s_add_u32 s69, s69, 8192
  buffer_load_dword v50, v3, s[56:59], s69 offen nt
  s_add_u32 s69, s69, 8192
  buffer_load_dword v51, v3, s[56:59], s69 offen nt
  v_lshlrev_b32 v152, 3, v1
  s_lshl_b32 s66, s2, 13
  s_add_u32 s66, s66, 1048576
  s_lshl_b32 s65, s43, 16
  s_add_u32 s65, s65, 1048576
  s_lshl_b32 s78, s45, 9
  s_add_u32 s78, s78, s66
  v_add_u32 v154, s78, v152
  v_mov_b32 v6, 20992
  v_mov_b32 v7, 1
  s_waitcnt vmcnt(20)
  v_lshlrev_b32 v16, 16, v8
  v_and_b32 v17, s46, v8
  v_lshlrev_b32 v18, 16, v9
  v_and_b32 v19, s46, v9
  v_lshlrev_b32 v20, 16, v10
  v_and_b32 v21, s46, v10
  v_lshlrev_b32 v22, 16, v11
  v_and_b32 v23, s46, v11
  v_lshlrev_b32 v24, 16, v12
  v_and_b32 v25, s46, v12
  v_add_f32 v164, v16, v17
  v_add_f32 v164, v164, v18
  v_add_f32 v164, v164, v19
  v_add_f32 v164, v164, v20
  v_add_f32 v164, v164, v21
  v_add_f32 v164, v164, v22
  v_add_f32 v164, v164, v23
  v_add_f32 v164, v164, v24
  v_add_f32 v164, v164, v25
  s_nop 1
  v_add_f32_dpp v164, v164, v164 quad_perm:[1,0,3,2] row_mask:0xf bank_mask:0xf
  s_nop 1
  v_add_f32_dpp v164, v164, v164 quad_perm:[2,3,0,1] row_mask:0xf bank_mask:0xf
  s_nop 1
  v_add_f32_dpp v164, v164, v164 row_half_mirror row_mask:0xf bank_mask:0xf
  s_nop 1
  v_add_f32_dpp v164, v164, v164 row_mirror row_mask:0xf bank_mask:0xf
  s_nop 1
  v_add_f32_dpp v164, v164, v164 row_bcast:15 row_mask:0xa bank_mask:0xf
  s_nop 1
  v_add_f32_dpp v164, v164, v164 row_bcast:31 row_mask:0xc bank_mask:0xf
  s_nop 1
  v_readlane_b32 s76, v164, 63
  s_nop 1
  v_mov_b32 v165, s76
  v_mul_f32 v165, 0x3acccccd, v165
  v_sub_f32 v162, v16, v165
  v_mul_f32 v164, v162, v162
  v_sub_f32 v162, v17, v165
  v_fmac_f32 v164, v162, v162
  v_sub_f32 v162, v18, v165
  v_fmac_f32 v164, v162, v162
  v_sub_f32 v162, v19, v165
  v_fmac_f32 v164, v162, v162
  v_sub_f32 v162, v20, v165
  v_fmac_f32 v164, v162, v162
  v_sub_f32 v162, v21, v165
  v_fmac_f32 v164, v162, v162
  v_sub_f32 v162, v22, v165
  v_fmac_f32 v164, v162, v162
  v_sub_f32 v162, v23, v165
  v_fmac_f32 v164, v162, v162
  v_sub_f32 v162, v24, v165
  v_fmac_f32 v164, v162, v162
  v_sub_f32 v162, v25, v165
  v_fmac_f32 v164, v162, v162
  s_nop 1
  v_add_f32_dpp v164, v164, v164 quad_perm:[1,0,3,2] row_mask:0xf bank_mask:0xf
  s_nop 1
  v_add_f32_dpp v164, v164, v164 quad_perm:[2,3,0,1] row_mask:0xf bank_mask:0xf
  s_nop 1
  v_add_f32_dpp v164, v164, v164 row_half_mirror row_mask:0xf bank_mask:0xf
  s_nop 1
  v_add_f32_dpp v164, v164, v164 row_mirror row_mask:0xf bank_mask:0xf
  s_nop 1
  v_add_f32_dpp v164, v164, v164 row_bcast:15 row_mask:0xa bank_mask:0xf
  s_nop 1
  v_add_f32_dpp v164, v164, v164 row_bcast:31 row_mask:0xc bank_mask:0xf
  s_nop 1
  v_readlane_b32 s76, v164, 63
  s_nop 1
  v_mov_b32 v166, s76
  v_mul_f32 v166, 0x3acccccd, v166
  v_cvt_pk_bf16_f32 v166, v166, v166
  v_and_b32 v166, s46, v166
  v_add_f32 v166, 0x3727c5ac, v166
  v_cvt_pk_bf16_f32 v166, v166, v166
  v_and_b32 v166, s46, v166
  v_sqrt_f32 v166, v166
  s_nop 0
  v_cvt_pk_bf16_f32 v166, v166, v166
  v_and_b32 v166, s46, v166
  v_rcp_f32 v166, v166
  v_cvt_pk_bf16_f32 v165, v165, v165
  v_and_b32 v165, s46, v165
  v_sub_f32 v16, v16, v165
  v_sub_f32 v17, v17, v165
  v_sub_f32 v18, v18, v165
  v_sub_f32 v19, v19, v165
  v_sub_f32 v20, v20, v165
  v_sub_f32 v21, v21, v165
  v_sub_f32 v22, v22, v165
  v_sub_f32 v23, v23, v165
  v_sub_f32 v24, v24, v165
  v_sub_f32 v25, v25, v165
  v_cvt_pk_bf16_f32 v162, v16, v17
  v_lshlrev_b32 v16, 16, v162
  v_and_b32 v17, s46, v162
  v_cvt_pk_bf16_f32 v162, v18, v19
  v_lshlrev_b32 v18, 16, v162
  v_and_b32 v19, s46, v162
  v_cvt_pk_bf16_f32 v162, v20, v21
  v_lshlrev_b32 v20, 16, v162
  v_and_b32 v21, s46, v162
  v_cvt_pk_bf16_f32 v162, v22, v23
  v_lshlrev_b32 v22, 16, v162
  v_and_b32 v23, s46, v162
  v_cvt_pk_bf16_f32 v162, v24, v25
  v_lshlrev_b32 v24, 16, v162
  v_and_b32 v25, s46, v162
  v_mul_f32 v16, v16, v166
  v_mul_f32 v17, v17, v166
  v_mul_f32 v18, v18, v166
  v_mul_f32 v19, v19, v166
  v_mul_f32 v20, v20, v166
  v_mul_f32 v21, v21, v166
  v_mul_f32 v22, v22, v166
  v_mul_f32 v23, v23, v166
  v_mul_f32 v24, v24, v166
  v_mul_f32 v25, v25, v166
  v_cvt_pk_bf16_f32 v162, v16, v17
  v_lshlrev_b32 v16, 16, v162
  v_and_b32 v17, s46, v162
  v_cvt_pk_bf16_f32 v162, v18, v19
  v_lshlrev_b32 v18, 16, v162
  v_and_b32 v19, s46, v162
  v_cvt_pk_bf16_f32 v162, v20, v21
  v_lshlrev_b32 v20, 16, v162
  v_and_b32 v21, s46, v162
  v_cvt_pk_bf16_f32 v162, v22, v23
  v_lshlrev_b32 v22, 16, v162
  v_and_b32 v23, s46, v162
  v_cvt_pk_bf16_f32 v162, v24, v25
  v_lshlrev_b32 v24, 16, v162
  v_and_b32 v25, s46, v162
  s_mul_i32 s76, s45, 2560
  v_lshlrev_b32 v162, 5, v1
  v_add_u32 v162, s76, v162
  v_add_u32 v163, s76, v152
  ds_write_b128 v162, v[16:19] offset:0
  ds_write_b128 v162, v[20:23] offset:16
  ds_write_b64 v163, v[24:25] offset:2048
  s_mov_b64 exec, 1
  ds_add_u32 v6, v7 offset:4
  s_mov_b64 exec, -1
  s_lshl_b32 s77, s64, 2
  v_mov_b32 v162, s77
  v_mov_b32 v144, 0
  v_mov_b32 v145, 0
  v_mov_b32 v146, 0
  v_mov_b32 v147, 0
  v_mov_b32 v148, 0
  v_mov_b32 v149, 0
  v_mov_b32 v150, 0
  v_mov_b32 v151, 0
L_lw_1:
  ds_read_b32 v163, v6 offset:4
  s_waitcnt lgkmcnt(0)
  v_readfirstlane_b32 s76, v163
  s_nop 1
  s_cmp_ge_u32 s76, 4
  s_cbranch_scc1 L_lwok_2
  s_sleep 1
  s_cmp_eq_u32 s83, 0
  s_cbranch_scc1 L_to_3
  s_sub_u32 s83, s83, 1
  s_branch L_lw_1
L_to_3:
L_lwok_2:
  ds_read_b128 v[64:67], v162 offset:0
  ds_read_b128 v[68:71], v162 offset:16
  ds_read_b128 v[72:75], v162 offset:32
  ds_read_b128 v[76:79], v162 offset:48
  ds_read_b128 v[80:83], v162 offset:64
  ds_read_b128 v[84:87], v162 offset:2560
  ds_read_b128 v[88:91], v162 offset:2576
  ds_read_b128 v[92:95], v162 offset:2592
  ds_read_b128 v[96:99], v162 offset:2608
  ds_read_b128 v[100:103], v162 offset:2624
  ds_read_b128 v[104:107], v162 offset:5120
  ds_read_b128 v[108:111], v162 offset:5136
  ds_read_b128 v[112:115], v162 offset:5152
  ds_read_b128 v[116:119], v162 offset:5168
  ds_read_b128 v[120:123], v162 offset:5184
  ds_read_b128 v[124:127], v162 offset:7680
  ds_read_b128 v[128:131], v162 offset:7696
  ds_read_b128 v[132:135], v162 offset:7712
  ds_read_b128 v[136:139], v162 offset:7728
  ds_read_b128 v[140:143], v162 offset:7744
  s_waitcnt vmcnt(0) lgkmcnt(0)
  v_lshlrev_b32 v162, 16, v32
  v_and_b32 v163, s46, v32
  v_pk_fma_f32 v[144:145], v[162:163], v[64:65], v[144:145] op_sel_hi:[1,0,1]
  v_pk_fma_f32 v[146:147], v[162:163], v[84:85], v[146:147] op_sel_hi:[1,0,1]
  v_pk_fma_f32 v[148:149], v[162:163], v[104:105], v[148:149] op_sel_hi:[1,0,1]
  v_pk_fma_f32 v[150:151], v[162:163], v[124:125], v[150:151] op_sel_hi:[1,0,1]
  v_lshlrev_b32 v164, 16, v33
  v_and_b32 v165, s46, v33
  v_pk_fma_f32 v[144:145], v[164:165], v[64:65], v[144:145] op_sel:[0,1,0] op_sel_hi:[1,1,1]
  v_pk_fma_f32 v[146:147], v[164:165], v[84:85], v[146:147] op_sel:[0,1,0] op_sel_hi:[1,1,1]
  v_pk_fma_f32 v[148:149], v[164:165], v[104:105], v[148:149] op_sel:[0,1,0] op_sel_hi:[1,1,1]
  v_pk_fma_f32 v[150:151], v[164:165], v[124:125], v[150:151] op_sel:[0,1,0] op_sel_hi:[1,1,1]
  v_lshlrev_b32 v166, 16, v34
  v_and_b32 v167, s46, v34
  v_pk_fma_f32 v[144:145], v[166:167], v[66:67], v[144:145] op_sel_hi:[1,0,1]
  v_pk_fma_f32 v[146:147], v[166:167], v[86:87], v[146:147] op_sel_hi:[1,0,1]
  v_pk_fma_f32 v[148:149], v[166:167], v[106:107], v[148:149] op_sel_hi:[1,0,1]
  v_pk_fma_f32 v[150:151], v[166:167], v[126:127], v[150:151] op_sel_hi:[1,0,1]
  v_lshlrev_b32 v162, 16, v35
  v_and_b32 v163, s46, v35
  v_pk_fma_f32 v[144:145], v[162:163], v[66:67], v[144:145] op_sel:[0,1,0] op_sel_hi:[1,1,1]
  v_pk_fma_f32 v[146:147], v[162:163], v[86:87], v[146:147] op_sel:[0,1,0] op_sel_hi:[1,1,1]
  v_pk_fma_f32 v[148:149], v[162:163], v[106:107], v[148:149] op_sel:[0,1,0] op_sel_hi:[1,1,1]
  v_pk_fma_f32 v[150:151], v[162:163], v[126:127], v[150:151] op_sel:[0,1,0] op_sel_hi:[1,1,1]
  v_lshlrev_b32 v164, 16, v36
  v_and_b32 v165, s46, v36
  v_pk_fma_f32 v[144:145], v[164:165], v[68:69], v[144:145] op_sel_hi:[1,0,1]
  v_pk_fma_f32 v[146:147], v[164:165], v[88:89], v[146:147] op_sel_hi:[1,0,1]
  v_pk_fma_f32 v[148:149], v[164:165], v[108:109], v[148:149] op_sel_hi:[1,0,1]
  v_pk_fma_f32 v[150:151], v[164:165], v[128:129], v[150:151] op_sel_hi:[1,0,1]
  v_lshlrev_b32 v166, 16, v37
  v_and_b32 v167, s46, v37
  v_pk_fma_f32 v[144:145], v[166:167], v[68:69], v[144:145] op_sel:[0,1,0] op_sel_hi:[1,1,1]
  v_pk_fma_f32 v[146:147], v[166:167], v[88:89], v[146:147] op_sel:[0,1,0] op_sel_hi:[1,1,1]
  v_pk_fma_f32 v[148:149], v[166:167], v[108:109], v[148:149] op_sel:[0,1,0] op_sel_hi:[1,1,1]
  v_pk_fma_f32 v[150:151], v[166:167], v[128:129], v[150:151] op_sel:[0,1,0] op_sel_hi:[1,1,1]
  v_lshlrev_b32 v162, 16, v38
  v_and_b32 v163, s46, v38
  v_pk_fma_f32 v[144:145], v[162:163], v[70:71], v[144:145] op_sel_hi:[1,0,1]
  v_pk_fma_f32 v[146:147], v[162:163], v[90:91], v[146:147] op_sel_hi:[1,0,1]
  v_pk_fma_f32 v[148:149], v[162:163], v[110:111], v[148:149] op_sel_hi:[1,0,1]
  v_pk_fma_f32 v[150:151], v[162:163], v[130:131], v[150:151] op_sel_hi:[1,0,1]
  v_lshlrev_b32 v164, 16, v39
  v_and_b32 v165, s46, v39
  v_pk_fma_f32 v[144:145], v[164:165], v[70:71], v[144:145] op_sel:[0,1,0] op_sel_hi:[1,1,1]
  v_pk_fma_f32 v[146:147], v[164:165], v[90:91], v[146:147] op_sel:[0,1,0] op_sel_hi:[1,1,1]
  v_pk_fma_f32 v[148:149], v[164:165], v[110:111], v[148:149] op_sel:[0,1,0] op_sel_hi:[1,1,1]
  v_pk_fma_f32 v[150:151], v[164:165], v[130:131], v[150:151] op_sel:[0,1,0] op_sel_hi:[1,1,1]
  v_lshlrev_b32 v166, 16, v40
  v_and_b32 v167, s46, v40
  v_pk_fma_f32 v[144:145], v[166:167], v[72:73], v[144:145] op_sel_hi:[1,0,1]
  v_pk_fma_f32 v[146:147], v[166:167], v[92:93], v[146:147] op_sel_hi:[1,0,1]
  v_pk_fma_f32 v[148:149], v[166:167], v[112:113], v[148:149] op_sel_hi:[1,0,1]
  v_pk_fma_f32 v[150:151], v[166:167], v[132:133], v[150:151] op_sel_hi:[1,0,1]
  v_lshlrev_b32 v162, 16, v41
  v_and_b32 v163, s46, v41
  v_pk_fma_f32 v[144:145], v[162:163], v[72:73], v[144:145] op_sel:[0,1,0] op_sel_hi:[1,1,1]
  v_pk_fma_f32 v[146:147], v[162:163], v[92:93], v[146:147] op_sel:[0,1,0] op_sel_hi:[1,1,1]
  v_pk_fma_f32 v[148:149], v[162:163], v[112:113], v[148:149] op_sel:[0,1,0] op_sel_hi:[1,1,1]
  v_pk_fma_f32 v[150:151], v[162:163], v[132:133], v[150:151] op_sel:[0,1,0] op_sel_hi:[1,1,1]
  v_lshlrev_b32 v164, 16, v42
  v_and_b32 v165, s46, v42
  v_pk_fma_f32 v[144:145], v[164:165], v[74:75], v[144:145] op_sel_hi:[1,0,1]
  v_pk_fma_f32 v[146:147], v[164:165], v[94:95], v[146:147] op_sel_hi:[1,0,1]
  v_pk_fma_f32 v[148:149], v[164:165], v[114:115], v[148:149] op_sel_hi:[1,0,1]
  v_pk_fma_f32 v[150:151], v[164:165], v[134:135], v[150:151] op_sel_hi:[1,0,1]
  v_lshlrev_b32 v166, 16, v43
  v_and_b32 v167, s46, v43
  v_pk_fma_f32 v[144:145], v[166:167], v[74:75], v[144:145] op_sel:[0,1,0] op_sel_hi:[1,1,1]
  v_pk_fma_f32 v[146:147], v[166:167], v[94:95], v[146:147] op_sel:[0,1,0] op_sel_hi:[1,1,1]
  v_pk_fma_f32 v[148:149], v[166:167], v[114:115], v[148:149] op_sel:[0,1,0] op_sel_hi:[1,1,1]
  v_pk_fma_f32 v[150:151], v[166:167], v[134:135], v[150:151] op_sel:[0,1,0] op_sel_hi:[1,1,1]
  v_lshlrev_b32 v162, 16, v44
  v_and_b32 v163, s46, v44
  v_pk_fma_f32 v[144:145], v[162:163], v[76:77], v[144:145] op_sel_hi:[1,0,1]
  v_pk_fma_f32 v[146:147], v[162:163], v[96:97], v[146:147] op_sel_hi:[1,0,1]
  v_pk_fma_f32 v[148:149], v[162:163], v[116:117], v[148:149] op_sel_hi:[1,0,1]
  v_pk_fma_f32 v[150:151], v[162:163], v[136:137], v[150:151] op_sel_hi:[1,0,1]
  v_lshlrev_b32 v164, 16, v45
  v_and_b32 v165, s46, v45
  v_pk_fma_f32 v[144:145], v[164:165], v[76:77], v[144:145] op_sel:[0,1,0] op_sel_hi:[1,1,1]
  v_pk_fma_f32 v[146:147], v[164:165], v[96:97], v[146:147] op_sel:[0,1,0] op_sel_hi:[1,1,1]
  v_pk_fma_f32 v[148:149], v[164:165], v[116:117], v[148:149] op_sel:[0,1,0] op_sel_hi:[1,1,1]
  v_pk_fma_f32 v[150:151], v[164:165], v[136:137], v[150:151] op_sel:[0,1,0] op_sel_hi:[1,1,1]
  v_lshlrev_b32 v166, 16, v46
  v_and_b32 v167, s46, v46
  v_pk_fma_f32 v[144:145], v[166:167], v[78:79], v[144:145] op_sel_hi:[1,0,1]
  v_pk_fma_f32 v[146:147], v[166:167], v[98:99], v[146:147] op_sel_hi:[1,0,1]
  v_pk_fma_f32 v[148:149], v[166:167], v[118:119], v[148:149] op_sel_hi:[1,0,1]
  v_pk_fma_f32 v[150:151], v[166:167], v[138:139], v[150:151] op_sel_hi:[1,0,1]
  v_lshlrev_b32 v162, 16, v47
  v_and_b32 v163, s46, v47
  v_pk_fma_f32 v[144:145], v[162:163], v[78:79], v[144:145] op_sel:[0,1,0] op_sel_hi:[1,1,1]
  v_pk_fma_f32 v[146:147], v[162:163], v[98:99], v[146:147] op_sel:[0,1,0] op_sel_hi:[1,1,1]
  v_pk_fma_f32 v[148:149], v[162:163], v[118:119], v[148:149] op_sel:[0,1,0] op_sel_hi:[1,1,1]
  v_pk_fma_f32 v[150:151], v[162:163], v[138:139], v[150:151] op_sel:[0,1,0] op_sel_hi:[1,1,1]
  v_lshlrev_b32 v164, 16, v48
  v_and_b32 v165, s46, v48
  v_pk_fma_f32 v[144:145], v[164:165], v[80:81], v[144:145] op_sel_hi:[1,0,1]
  v_pk_fma_f32 v[146:147], v[164:165], v[100:101], v[146:147] op_sel_hi:[1,0,1]
  v_pk_fma_f32 v[148:149], v[164:165], v[120:121], v[148:149] op_sel_hi:[1,0,1]
  v_pk_fma_f32 v[150:151], v[164:165], v[140:141], v[150:151] op_sel_hi:[1,0,1]
  v_lshlrev_b32 v166, 16, v49
  v_and_b32 v167, s46, v49
  v_pk_fma_f32 v[144:145], v[166:167], v[80:81], v[144:145] op_sel:[0,1,0] op_sel_hi:[1,1,1]
  v_pk_fma_f32 v[146:147], v[166:167], v[100:101], v[146:147] op_sel:[0,1,0] op_sel_hi:[1,1,1]
  v_pk_fma_f32 v[148:149], v[166:167], v[120:121], v[148:149] op_sel:[0,1,0] op_sel_hi:[1,1,1]
  v_pk_fma_f32 v[150:151], v[166:167], v[140:141], v[150:151] op_sel:[0,1,0] op_sel_hi:[1,1,1]
  v_lshlrev_b32 v162, 16, v50
  v_and_b32 v163, s46, v50
  v_pk_fma_f32 v[144:145], v[162:163], v[82:83], v[144:145] op_sel_hi:[1,0,1]
  v_pk_fma_f32 v[146:147], v[162:163], v[102:103], v[146:147] op_sel_hi:[1,0,1]
  v_pk_fma_f32 v[148:149], v[162:163], v[122:123], v[148:149] op_sel_hi:[1,0,1]
  v_pk_fma_f32 v[150:151], v[162:163], v[142:143], v[150:151] op_sel_hi:[1,0,1]
  v_lshlrev_b32 v164, 16, v51
  v_and_b32 v165, s46, v51
  v_pk_fma_f32 v[144:145], v[164:165], v[82:83], v[144:145] op_sel:[0,1,0] op_sel_hi:[1,1,1]
  v_pk_fma_f32 v[146:147], v[164:165], v[102:103], v[146:147] op_sel:[0,1,0] op_sel_hi:[1,1,1]
  v_pk_fma_f32 v[148:149], v[164:165], v[122:123], v[148:149] op_sel:[0,1,0] op_sel_hi:[1,1,1]
  v_pk_fma_f32 v[150:151], v[164:165], v[142:143], v[150:151] op_sel:[0,1,0] op_sel_hi:[1,1,1]
  s_lshl_b32 s76, s45, 11
  v_add_u32 v153, s76, v152
  ds_write_b64 v153, v[144:145] offset:10240
  ds_write_b64 v153, v[146:147] offset:10752
  ds_write_b64 v153, v[148:149] offset:11264
  ds_write_b64 v153, v[150:151] offset:11776
  s_mov_b64 exec, 1
  ds_add_u32 v6, v7 offset:8
  s_mov_b64 exec, -1
  s_lshl_b32 s76, s45, 9
  v_add_u32 v153, s76, v152
L_lw_4:
  ds_read_b32 v156, v6 offset:8
  s_waitcnt lgkmcnt(0)
  v_readfirstlane_b32 s76, v156
  s_nop 1
  s_cmp_ge_u32 s76, 4
  s_cbranch_scc1 L_lwok_5
  s_sleep 1
  s_cmp_eq_u32 s83, 0
  s_cbranch_scc1 L_to_6
  s_sub_u32 s83, s83, 1
  s_branch L_lw_4
L_to_6:
L_lwok_5:
  ds_read_b64 v[144:145], v153 offset:10240
  ds_read_b64 v[146:147], v153 offset:12288
  ds_read_b64 v[148:149], v153 offset:14336
  ds_read_b64 v[150:151], v153 offset:16384
  s_waitcnt lgkmcnt(0)
  v_pk_add_f32 v[144:145], v[144:145], v[146:147]
  v_pk_add_f32 v[148:149], v[148:149], v[150:151]
  v_pk_add_f32 v[144:145], v[144:145], v[148:149]
L_lw_7:
  ds_read_b32 v156, v6 offset:0
  s_waitcnt lgkmcnt(0)
  v_readfirstlane_b32 s76, v156
  s_nop 1
  s_cmp_ge_u32 s76, 1
  s_cbranch_scc1 L_lwok_8
  s_sleep 1
  s_cmp_eq_u32 s83, 0
  s_cbranch_scc1 L_to_9
  s_sub_u32 s83, s83, 1
  s_branch L_lw_7
L_to_9:
L_lwok_8:
  global_store_dwordx2 v154, v[144:145], s[40:41] sc1
  s_lshl_b32 s78, s45, 9
  s_add_u32 s78, s78, s65
  s_add_u32 s79, s78, 0
  v_add_u32 v80, s79, v152
  s_add_u32 s79, s78, 8192
  v_add_u32 v81, s79, v152
  s_add_u32 s79, s78, 16384
  v_add_u32 v82, s79, v152
  s_add_u32 s79, s78, 24576
  v_add_u32 v83, s79, v152
  s_add_u32 s79, s78, 32768
  v_add_u32 v84, s79, v152
  s_add_u32 s79, s78, 40960
  v_add_u32 v85, s79, v152
  s_add_u32 s79, s78, 49152
  v_add_u32 v86, s79, v152
  s_add_u32 s79, s78, 57344
  v_add_u32 v87, s79, v152
  s_cmp_eq_u32 s45, 0
  s_cbranch_scc0 L_h_b4
  s_add_u32 s76, s66, 7296
  v_mov_b32 v156, s76
L_qpoll:
  global_load_dword v158, v156, s[40:41] sc1
  s_waitcnt vmcnt(0)
  v_readfirstlane_b32 s77, v158
  s_nop 1
  s_cmp_eq_u32 s77, 1
  s_cbranch_scc1 L_qok
  s_sleep 2
  s_cmp_eq_u32 s83, 0
  s_cbranch_scc1 L_to_10
  s_sub_u32 s83, s83, 1
  s_branch L_qpoll
L_to_10:
L_qok:
  s_mov_b64 exec, 1
  ds_add_u32 v6, v7 offset:16
  s_mov_b64 exec, -1
L_h_b4:
L_lw_11:
  ds_read_b32 v156, v6 offset:16
  s_waitcnt lgkmcnt(0)
  v_readfirstlane_b32 s76, v156
  s_nop 1
  s_cmp_ge_u32 s76, 1
  s_cbranch_scc1 L_lwok_12
  s_sleep 1
  s_cmp_eq_u32 s83, 0
  s_cbranch_scc1 L_to_13
  s_sub_u32 s83, s83, 1
  s_branch L_lw_11
L_to_13:
L_lwok_12:
L_qg:
  global_load_dwordx2 v[64:65], v80, s[40:41] sc1
  global_load_dwordx2 v[66:67], v81, s[40:41] sc1
  global_load_dwordx2 v[68:69], v82, s[40:41] sc1
  global_load_dwordx2 v[70:71], v83, s[40:41] sc1
  global_load_dwordx2 v[72:73], v84, s[40:41] sc1
  global_load_dwordx2 v[74:75], v85, s[40:41] sc1
  global_load_dwordx2 v[76:77], v86, s[40:41] sc1
  global_load_dwordx2 v[78:79], v87, s[40:41] sc1
  s_waitcnt vmcnt(0)
  v_max3_u32 v156, v64, v65, v66
  v_max3_u32 v156, v156, v67, v68
  v_max3_u32 v156, v156, v69, v70
  v_max3_u32 v156, v156, v71, v72
  v_max3_u32 v156, v156, v73, v74
  v_max3_u32 v156, v156, v75, v76
  v_max3_u32 v156, v156, v77, v78
  v_max_u32 v156, v156, v79
  v_cmp_eq_u32 vcc, -1, v156
  s_nop 4
  s_cbranch_vccz L_qgok
  s_cmp_eq_u32 s83, 0
  s_cbranch_scc1 L_to_14
  s_sub_u32 s83, s83, 1
  s_branch L_qg
L_to_14:
L_qgok:
  v_pk_add_f32 v[64:65], v[64:65], v[66:67]
  v_pk_add_f32 v[64:65], v[64:65], v[68:69]
  v_pk_add_f32 v[64:65], v[64:65], v[70:71]
  v_pk_add_f32 v[64:65], v[64:65], v[72:73]
  v_pk_add_f32 v[64:65], v[64:65], v[74:75]
  v_pk_add_f32 v[64:65], v[64:65], v[76:77]
  v_pk_add_f32 v[64:65], v[64:65], v[78:79]
  v_cvt_pk_bf16_f32 v156, v64, v65
  s_lshl_b32 s76, s45, 8
  v_add_u32 v157, s76, v3
  ds_write_b32 v157, v156 offset:18432
  s_mov_b64 exec, 1
  ds_add_u32 v6, v7 offset:20
  s_mov_b64 exec, -1
  s_branch L_h_post
L_swave:
  v_lshlrev_b32 v2, 4, v1
  s_cmp_eq_u32 s42, 0
  s_cbranch_scc0 L_s_nop0
  s_setprio 3
  v_mov_b32 v40, -1
  v_mov_b32 v41, -1
  v_mov_b32 v42, -1
  v_mov_b32 v43, -1
  s_lshl_b32 s76, s2, 13
  s_add_u32 s76, s76, 1048576
  v_add_u32 v44, s76, v2
  v_add_u32 v45, 4096, v44
  global_store_dwordx4 v44, v[40:43], s[40:41] offset:0 sc1
  global_store_dwordx4 v44, v[40:43], s[40:41] offset:1024 sc1
  global_store_dwordx4 v44, v[40:43], s[40:41] offset:2048 sc1
  global_store_dwordx4 v44, v[40:43], s[40:41] offset:3072 sc1
  global_store_dwordx4 v45, v[40:43], s[40:41] offset:0 sc1
  global_store_dwordx4 v45, v[40:43], s[40:41] offset:1024 sc1
  global_store_dwordx4 v45, v[40:43], s[40:41] offset:2048 sc1
  global_store_dwordx4 v45, v[40:43], s[40:41] offset:3072 sc1
  s_lshl_b32 s76, s43, 8
  s_lshl_b32 s77, s44, 3
  s_add_u32 s77, s77, s76
  s_add_u32 s77, s77, 65536
  v_lshlrev_b32 v46, 6, v1
  v_add_u32 v46, s77, v46
  s_mul_i32 s78, s43, 256
  s_add_u32 s78, s78, 131072
  v_lshlrev_b32 v47, 7, v1
  v_add_u32 v47, s78, v47
  v_mov_b32 v36, 0
  s_mov_b64 exec, 0xf
  global_store_dwordx2 v46, v[40:41], s[40:41] sc1
  s_mov_b64 exec, 3
  s_cmp_eq_u32 s44, 0
  s_cbranch_scc0 L_noctr
  global_store_dword v47, v36, s[40:41] sc1
L_noctr:
  s_mov_b64 exec, 1
  s_lshr_b32 s77, s43, 4
  s_lshl_b32 s77, s77, 5
  s_and_b32 s78, s43, 15
  s_add_u32 s77, s77, s78
  s_lshl_b32 s77, s77, 2
  v_mov_b32 v46, s77
  v_mov_b32 v36, 1
  v_mov_b32 v38, 20992
  s_waitcnt vmcnt(0)
  global_atomic_add v47, v46, v36, s[38:39] sc0
  ds_write_b32 v38, v36
  s_waitcnt vmcnt(0)
  v_readfirstlane_b32 s76, v47
  s_mov_b64 exec, -1
  s_nop 0
  s_and_b32 s76, s76, 7
  s_cmp_eq_u32 s76, 7
  s_cbranch_scc0 L_s_nogo
  s_lshl_b32 s77, s43, 16
  s_add_u32 s77, s77, 1055872
  v_lshlrev_b32 v44, 13, v1
  v_add_u32 v44, s77, v44
  v_mov_b32 v36, 1
  s_mov_b64 exec, 0xff
  global_store_dword v44, v36, s[40:41] sc1
  s_mov_b64 exec, -1
L_s_nogo:
  s_setprio 0
L_s_nop0:
  s_lshl_b32 s65, s43, 21
  s_lshr_b32 s70, s44, 1
  s_lshl_b32 s76, s70, 26
  s_and_b32 s77, s44, 1
  s_lshl_b32 s77, s77, 20
  s_add_u32 s64, s65, s76
  s_add_u32 s64, s64, s77
  s_lshl_b32 s76, s42, 12
  s_add_u32 s64, s64, s76
  s_mov_b32 s48, s18
  s_mov_b32 s49, s19
  s_mov_b32 s50, 268435456
  s_mov_b32 s51, 0x20000
  s_mov_b32 s56, s40
  s_mov_b32 s57, s41
  s_mov_b32 s58, 1048576
  s_mov_b32 s59, 0x20000
  v_mov_b32 v38, 20992
  s_mul_i32 s76, s43, 256
  s_add_u32 s76, s76, 131072
  v_mov_b32 v60, s76
  v_add_u32 v61, 128, v60
  s_mul_i32 s6, s42, 16384
  s_add_u32 s6, s6, 88064
  s_add_u32 s69, s64, 0
  buffer_load_dwordx4 v[128:131], v2, s[48:51], s69 offen offset:0 nt
  buffer_load_dwordx4 v[132:135], v2, s[48:51], s69 offen offset:1024 nt
  buffer_load_dwordx4 v[136:139], v2, s[48:51], s69 offen offset:2048 nt
  buffer_load_dwordx4 v[140:143], v2, s[48:51], s69 offen offset:3072 nt
  s_add_u32 s69, s64, 16384
  buffer_load_dwordx4 v[144:147], v2, s[48:51], s69 offen offset:0 nt
  buffer_load_dwordx4 v[148:151], v2, s[48:51], s69 offen offset:1024 nt
  buffer_load_dwordx4 v[152:155], v2, s[48:51], s69 offen offset:2048 nt
  buffer_load_dwordx4 v[156:159], v2, s[48:51], s69 offen offset:3072 nt
  s_add_u32 s69, s64, 32768
  buffer_load_dwordx4 v[160:163], v2, s[48:51], s69 offen offset:0 nt
  buffer_load_dwordx4 v[164:167], v2, s[48:51], s69 offen offset:1024 nt
  buffer_load_dwordx4 v[168:171], v2, s[48:51], s69 offen offset:2048 nt
  buffer_load_dwordx4 v[172:175], v2, s[48:51], s69 offen offset:3072 nt
  s_add_u32 s69, s64, 49152
  s_waitcnt vmcnt(11)
  buffer_load_dwordx4 v[176:179], v2, s[48:51], s69 offen offset:0 nt
  s_waitcnt vmcnt(11)
  buffer_load_dwordx4 v[180:183], v2, s[48:51], s69 offen offset:1024 nt
  s_waitcnt vmcnt(11)
  buffer_load_dwordx4 v[184:187], v2, s[48:51], s69 offen offset:2048 nt
  s_waitcnt vmcnt(11)
  buffer_load_dwordx4 v[188:191], v2, s[48:51], s69 offen offset:3072 nt
  s_add_u32 s69, s64, 65536
  s_waitcnt vmcnt(11)
  buffer_load_dwordx4 v[192:195], v2, s[48:51], s69 offen offset:0 nt
  s_waitcnt vmcnt(11)
  buffer_load_dwordx4 v[196:199], v2, s[48:51], s69 offen offset:1024 nt
  s_waitcnt vmcnt(11)
  buffer_load_dwordx4 v[200:203], v2, s[48:51], s69 offen offset:2048 nt
  s_waitcnt vmcnt(11)
  buffer_load_dwordx4 v[204:207], v2, s[48:51], s69 offen offset:3072 nt
  s_add_u32 s69, s64, 81920
  s_waitcnt vmcnt(11)
  buffer_load_dwordx4 v[208:211], v2, s[48:51], s69 offen offset:0 nt
  s_waitcnt vmcnt(11)
  buffer_load_dwordx4 v[212:215], v2, s[48:51], s69 offen offset:1024 nt
  s_waitcnt vmcnt(11)
  buffer_load_dwordx4 v[216:219], v2, s[48:51], s69 offen offset:2048 nt
  s_waitcnt vmcnt(11)
  buffer_load_dwordx4 v[220:223], v2, s[48:51], s69 offen offset:3072 nt
  s_add_u32 s69, s64, 98304
  s_waitcnt vmcnt(11)
  buffer_load_dwordx4 v[224:227], v2, s[48:51], s69 offen offset:0 nt
  s_waitcnt vmcnt(11)
  buffer_load_dwordx4 v[228:231], v2, s[48:51], s69 offen offset:1024 nt
  s_waitcnt vmcnt(11)
  buffer_load_dwordx4 v[232:235], v2, s[48:51], s69 offen offset:2048 nt
  s_waitcnt vmcnt(11)
  buffer_load_dwordx4 v[236:239], v2, s[48:51], s69 offen offset:3072 nt
  s_add_u32 s69, s64, 114688
  s_waitcnt vmcnt(11)
  buffer_load_dwordx4 v[240:243], v2, s[48:51], s69 offen offset:0 nt
  s_waitcnt vmcnt(11)
  buffer_load_dwordx4 v[244:247], v2, s[48:51], s69 offen offset:1024 nt
  s_waitcnt vmcnt(11)
  buffer_load_dwordx4 v[248:251], v2, s[48:51], s69 offen offset:2048 nt
  s_waitcnt vmcnt(11)
  buffer_load_dwordx4 v[252:255], v2, s[48:51], s69 offen offset:3072 nt
  s_add_u32 s69, s64, 131072
  s_add_u32 m0, s6, 0
  s_waitcnt vmcnt(11)
  buffer_load_dwordx4 v2, s[48:51], s69 offen offset:0 nt lds
  s_waitcnt vmcnt(11)
  buffer_load_dwordx4 v2, s[48:51], s69 offen offset:1024 nt lds
  s_waitcnt vmcnt(11)
  buffer_load_dwordx4 v2, s[48:51], s69 offen offset:2048 nt lds
  s_waitcnt vmcnt(11)
  buffer_load_dwordx4 v2, s[48:51], s69 offen offset:3072 nt lds
  s_add_u32 s69, s64, 147456
  s_add_u32 m0, s6, 4096
  s_waitcnt vmcnt(11)
  buffer_load_dwordx4 v2, s[48:51], s69 offen offset:0 nt lds
  s_waitcnt vmcnt(11)
  buffer_load_dwordx4 v2, s[48:51], s69 offen offset:1024 nt lds
  s_waitcnt vmcnt(11)
  buffer_load_dwordx4 v2, s[48:51], s69 offen offset:2048 nt lds
  s_waitcnt vmcnt(11)
  buffer_load_dwordx4 v2, s[48:51], s69 offen offset:3072 nt lds
  s_add_u32 s69, s64, 163840
  s_add_u32 m0, s6, 8192
  s_waitcnt vmcnt(11)
  buffer_load_dwordx4 v2, s[48:51], s69 offen offset:0 nt lds
  s_waitcnt vmcnt(11)
  buffer_load_dwordx4 v2, s[48:51], s69 offen offset:1024 nt lds
  s_waitcnt vmcnt(11)
  buffer_load_dwordx4 v2, s[48:51], s69 offen offset:2048 nt lds
  s_waitcnt vmcnt(11)
  buffer_load_dwordx4 v2, s[48:51], s69 offen offset:3072 nt lds
  s_add_u32 s69, s64, 180224
  s_add_u32 m0, s6, 12288
  s_waitcnt vmcnt(11)
  buffer_load_dwordx4 v2, s[48:51], s69 offen offset:0 nt lds
  s_waitcnt vmcnt(11)
  buffer_load_dwordx4 v2, s[48:51], s69 offen offset:1024 nt lds
  s_waitcnt vmcnt(11)
  buffer_load_dwordx4 v2, s[48:51], s69 offen offset:2048 nt lds
  s_waitcnt vmcnt(11)
  buffer_load_dwordx4 v2, s[48:51], s69 offen offset:3072 nt lds
  s_add_u32 s69, s64, 196608
  s_waitcnt vmcnt(11)
  buffer_load_dwordx4 v[64:67], v2, s[48:51], s69 offen offset:0 nt
  s_waitcnt vmcnt(11)
  buffer_load_dwordx4 v[68:71], v2, s[48:51], s69 offen offset:1024 nt
  s_waitcnt vmcnt(11)
  buffer_load_dwordx4 v[72:75], v2, s[48:51], s69 offen offset:2048 nt
  s_waitcnt vmcnt(11)
  buffer_load_dwordx4 v[76:79], v2, s[48:51], s69 offen offset:3072 nt
  s_add_u32 s69, s64, 212992
  s_waitcnt vmcnt(11)
  buffer_load_dwordx4 v[80:83], v2, s[48:51], s69 offen offset:0 nt
  s_waitcnt vmcnt(11)
  buffer_load_dwordx4 v[84:87], v2, s[48:51], s69 offen offset:1024 nt
  s_waitcnt vmcnt(11)
  buffer_load_dwordx4 v[88:91], v2, s[48:51], s69 offen offset:2048 nt
  s_waitcnt vmcnt(11)
  buffer_load_dwordx4 v[92:95], v2, s[48:51], s69 offen offset:3072 nt
  s_add_u32 s69, s64, 229376
  s_waitcnt vmcnt(11)
  buffer_load_dwordx4 v[96:99], v2, s[48:51], s69 offen offset:0 nt
  s_waitcnt vmcnt(11)
  buffer_load_dwordx4 v[100:103], v2, s[48:51], s69 offen offset:1024 nt
  s_waitcnt vmcnt(11)
  buffer_load_dwordx4 v[104:107], v2, s[48:51], s69 offen offset:2048 nt
  s_waitcnt vmcnt(11)
  buffer_load_dwordx4 v[108:111], v2, s[48:51], s69 offen offset:3072 nt
  s_add_u32 s69, s64, 245760
  s_waitcnt vmcnt(11)
  buffer_load_dwordx4 v[112:115], v2, s[48:51], s69 offen offset:0 nt
  s_waitcnt vmcnt(11)
  buffer_load_dwordx4 v[116:119], v2, s[48:51], s69 offen offset:1024 nt
  s_waitcnt vmcnt(11)
  buffer_load_dwordx4 v[120:123], v2, s[48:51], s69 offen offset:2048 nt
  s_waitcnt vmcnt(11)
  buffer_load_dwordx4 v[124:127], v2, s[48:51], s69 offen offset:3072 nt
  s_mul_i32 s76, s42, 16384
  v_lshlrev_b32 v4, 5, v1
  v_add_u32 v4, s76, v4
  v_add_u32 v4, 88064, v4
  v_lshrrev_b32 v5, 4, v1
  v_lshlrev_b32 v7, 4, v5
  s_lshl_b32 s76, s42, 12
  s_add_u32 s76, s76, 71680
  v_add_u32 v7, s76, v7
  s_lshl_b32 s76, s42, 2
  v_add_u32 v5, s76, v5
  v_lshlrev_b32 v5, 3, v5
  v_add_u32 v5, 21248, v5
  v_and_b32 v6, 15, v1
  v_lshlrev_b32 v6, 4, v6
  v_add_u32 v6, 18432, v6
  v_mov_b32 v12, 0
  v_mov_b32 v13, 0
  v_mov_b32 v14, 0
  v_mov_b32 v15, 0
  v_mov_b32 v16, 0
  v_mov_b32 v17, 0
  v_mov_b32 v18, 0
  v_mov_b32 v19, 0
  v_mov_b32 v20, 0xff7fffff
  v_mov_b32 v21, 0
  ds_write_b64 v5, v[20:21] offset:0
  ds_write_b64 v5, v[20:21] offset:128
  ds_write_b64 v5, v[20:21] offset:256
  ds_write_b64 v5, v[20:21] offset:384
L_lw_15:
  ds_read_b32 v36, v38 offset:20
  s_waitcnt lgkmcnt(0)
  v_readfirstlane_b32 s76, v36
  s_nop 1
  s_cmp_ge_u32 s76, 4
  s_cbranch_scc1 L_lwok_16
  s_sleep 1
  s_cmp_eq_u32 s83, 0
  s_cbranch_scc1 L_to_17
  s_sub_u32 s83, s83, 1
  s_branch L_lw_15
L_to_17:
L_lwok_16:
  s_lshl_b32 s76, s70, 8
  v_add_u32 v36, s76, v6
  ds_read_b128 v[8:11], v36
  s_mov_b32 s66, 16
  s_mov_b32 s67, 12
  s_mov_b32 s68, 0
  s_mov_b32 s5, 0
  s_mov_b32 s4, 0x7fffffff
  s_mov_b32 s73, s70
  s_mov_b32 s53, 12
  s_mov_b32 s74, s70
  s_mov_b32 s54, 13
  s_mov_b32 s75, s70
  s_mov_b32 s55, 14
  s_mov_b32 s52, s70
  s_mov_b32 s7, 15
  s_mov_b32 s72, 0
  s_mov_b32 s71, s70
  s_waitcnt lgkmcnt(0)
L_kloop:
  s_cmp_lt_u32 s72, 12
  s_cbranch_scc1 L_xK0
L_xK0_ret:
  s_waitcnt vmcnt(12)
  v_dot2_f32_bf16 v24, v64, v8, 0
  v_dot2_f32_bf16 v25, v68, v8, 0
  v_dot2_f32_bf16 v26, v72, v8, 0
  v_dot2_f32_bf16 v27, v76, v8, 0
  v_dot2_f32_bf16 v24, v65, v9, v24
  v_dot2_f32_bf16 v25, v69, v9, v25
  v_dot2_f32_bf16 v26, v73, v9, v26
  v_dot2_f32_bf16 v27, v77, v9, v27
  v_dot2_f32_bf16 v24, v66, v10, v24
  v_dot2_f32_bf16 v25, v70, v10, v25
  v_dot2_f32_bf16 v26, v74, v10, v26
  v_dot2_f32_bf16 v27, v78, v10, v27
  v_dot2_f32_bf16 v24, v67, v11, v24
  v_dot2_f32_bf16 v25, v71, v11, v25
  v_dot2_f32_bf16 v26, v75, v11, v26
  v_dot2_f32_bf16 v27, v79, v11, v27
  s_cmp_lt_u32 s66, 52
  s_cbranch_scc0 L_kd_K0
  s_mul_i32 s69, s66, 16384
  s_add_u32 s69, s69, s64
  s_add_u32 s66, s66, 1
L_kld_K0:
  buffer_load_dwordx4 v[64:67], v2, s[48:51], s69 offen offset:0 nt
  buffer_load_dwordx4 v[68:71], v2, s[48:51], s69 offen offset:1024 nt
  buffer_load_dwordx4 v[72:75], v2, s[48:51], s69 offen offset:2048 nt
  buffer_load_dwordx4 v[76:79], v2, s[48:51], s69 offen offset:3072 nt
  v_add_f32_dpp v24, v24, v24 quad_perm:[1,0,3,2] row_mask:0xf bank_mask:0xf
  v_add_f32_dpp v25, v25, v25 quad_perm:[1,0,3,2] row_mask:0xf bank_mask:0xf
  v_add_f32_dpp v26, v26, v26 quad_perm:[1,0,3,2] row_mask:0xf bank_mask:0xf
  v_add_f32_dpp v27, v27, v27 quad_perm:[1,0,3,2] row_mask:0xf bank_mask:0xf
  v_add_f32_dpp v24, v24, v24 quad_perm:[2,3,0,1] row_mask:0xf bank_mask:0xf
  v_add_f32_dpp v25, v25, v25 quad_perm:[2,3,0,1] row_mask:0xf bank_mask:0xf
  v_add_f32_dpp v26, v26, v26 quad_perm:[2,3,0,1] row_mask:0xf bank_mask:0xf
  v_add_f32_dpp v27, v27, v27 quad_perm:[2,3,0,1] row_mask:0xf bank_mask:0xf
  v_add_f32_dpp v24, v24, v24 row_half_mirror row_mask:0xf bank_mask:0xf
  v_add_f32_dpp v25, v25, v25 row_half_mirror row_mask:0xf bank_mask:0xf
  v_add_f32_dpp v26, v26, v26 row_half_mirror row_mask:0xf bank_mask:0xf
  v_add_f32_dpp v27, v27, v27 row_half_mirror row_mask:0xf bank_mask:0xf
  v_add_f32_dpp v24, v24, v24 row_mirror row_mask:0xf bank_mask:0xf
  v_add_f32_dpp v25, v25, v25 row_mirror row_mask:0xf bank_mask:0xf
  v_add_f32_dpp v26, v26, v26 row_mirror row_mask:0xf bank_mask:0xf
  v_add_f32_dpp v27, v27, v27 row_mirror row_mask:0xf bank_mask:0xf
  v_cvt_pk_bf16_f32 v28, v24, v25
  v_cvt_pk_bf16_f32 v29, v26, v27
  v_lshlrev_b32 v24, 16, v28
  v_and_b32 v25, s46, v28
  v_lshlrev_b32 v26, 16, v29
  v_and_b32 v27, s46, v29
  v_mul_f32 v24, s82, v24
  v_mul_f32 v25, s82, v25
  v_mul_f32 v26, s82, v26
  v_mul_f32 v27, s82, v27
  v_cvt_pk_bf16_f32 v28, v24, v25
  v_cvt_pk_bf16_f32 v29, v26, v27
  v_lshlrev_b32 v24, 16, v28
  v_and_b32 v25, s46, v28
  v_lshlrev_b32 v26, 16, v29
  v_and_b32 v27, s46, v29
  s_lshl_b32 s76, s67, 6
  v_add_u32 v36, s76, v7
  s_mov_b32 exec_lo, 0x00010001
  s_mov_b32 exec_hi, 0x00010001
  ds_write_b128 v36, v[24:27]
  s_mov_b64 exec, -1
  s_add_u32 s67, s67, 1
  s_cmp_ge_u32 s67, 52
  s_cbranch_scc1 L_V1_entry
  s_cmp_lt_u32 s72, 12
  s_cbranch_scc1 L_xK1
L_xK1_ret:
  s_waitcnt vmcnt(12)
  v_dot2_f32_bf16 v24, v80, v8, 0
  v_dot2_f32_bf16 v25, v84, v8, 0
  v_dot2_f32_bf16 v26, v88, v8, 0
  v_dot2_f32_bf16 v27, v92, v8, 0
  v_dot2_f32_bf16 v24, v81, v9, v24
  v_dot2_f32_bf16 v25, v85, v9, v25
  v_dot2_f32_bf16 v26, v89, v9, v26
  v_dot2_f32_bf16 v27, v93, v9, v27
  v_dot2_f32_bf16 v24, v82, v10, v24
  v_dot2_f32_bf16 v25, v86, v10, v25
  v_dot2_f32_bf16 v26, v90, v10, v26
  v_dot2_f32_bf16 v27, v94, v10, v27
  v_dot2_f32_bf16 v24, v83, v11, v24
  v_dot2_f32_bf16 v25, v87, v11, v25
  v_dot2_f32_bf16 v26, v91, v11, v26
  v_dot2_f32_bf16 v27, v95, v11, v27
  s_cmp_lt_u32 s66, 52
  s_cbranch_scc0 L_kd_K1
  s_mul_i32 s69, s66, 16384
  s_add_u32 s69, s69, s64
  s_add_u32 s66, s66, 1
L_kld_K1:
  buffer_load_dwordx4 v[80:83], v2, s[48:51], s69 offen offset:0 nt
  buffer_load_dwordx4 v[84:87], v2, s[48:51], s69 offen offset:1024 nt
  buffer_load_dwordx4 v[88:91], v2, s[48:51], s69 offen offset:2048 nt
  buffer_load_dwordx4 v[92:95], v2, s[48:51], s69 offen offset:3072 nt
  v_add_f32_dpp v24, v24, v24 quad_perm:[1,0,3,2] row_mask:0xf bank_mask:0xf
  v_add_f32_dpp v25, v25, v25 quad_perm:[1,0,3,2] row_mask:0xf bank_mask:0xf
  v_add_f32_dpp v26, v26, v26 quad_perm:[1,0,3,2] row_mask:0xf bank_mask:0xf
  v_add_f32_dpp v27, v27, v27 quad_perm:[1,0,3,2] row_mask:0xf bank_mask:0xf
  v_add_f32_dpp v24, v24, v24 quad_perm:[2,3,0,1] row_mask:0xf bank_mask:0xf
  v_add_f32_dpp v25, v25, v25 quad_perm:[2,3,0,1] row_mask:0xf bank_mask:0xf
  v_add_f32_dpp v26, v26, v26 quad_perm:[2,3,0,1] row_mask:0xf bank_mask:0xf
  v_add_f32_dpp v27, v27, v27 quad_perm:[2,3,0,1] row_mask:0xf bank_mask:0xf
  v_add_f32_dpp v24, v24, v24 row_half_mirror row_mask:0xf bank_mask:0xf
  v_add_f32_dpp v25, v25, v25 row_half_mirror row_mask:0xf bank_mask:0xf
  v_add_f32_dpp v26, v26, v26 row_half_mirror row_mask:0xf bank_mask:0xf
  v_add_f32_dpp v27, v27, v27 row_half_mirror row_mask:0xf bank_mask:0xf
  v_add_f32_dpp v24, v24, v24 row_mirror row_mask:0xf bank_mask:0xf
  v_add_f32_dpp v25, v25, v25 row_mirror row_mask:0xf bank_mask:0xf
  v_add_f32_dpp v26, v26, v26 row_mirror row_mask:0xf bank_mask:0xf
  v_add_f32_dpp v27, v27, v27 row_mirror row_mask:0xf bank_mask:0xf
  v_cvt_pk_bf16_f32 v28, v24, v25
  v_cvt_pk_bf16_f32 v29, v26, v27
  v_lshlrev_b32 v24, 16, v28
  v_and_b32 v25, s46, v28
  v_lshlrev_b32 v26, 16, v29
  v_and_b32 v27, s46, v29
  v_mul_f32 v24, s82, v24
  v_mul_f32 v25, s82, v25
  v_mul_f32 v26, s82, v26
  v_mul_f32 v27, s82, v27
  v_cvt_pk_bf16_f32 v28, v24, v25
  v_cvt_pk_bf16_f32 v29, v26, v27
  v_lshlrev_b32 v24, 16, v28
  v_and_b32 v25, s46, v28
  v_lshlrev_b32 v26, 16, v29
  v_and_b32 v27, s46, v29
  s_lshl_b32 s76, s67, 6
  v_add_u32 v36, s76, v7
  s_mov_b32 exec_lo, 0x00010001
  s_mov_b32 exec_hi, 0x00010001
  ds_write_b128 v36, v[24:27]
  s_mov_b64 exec, -1
  s_add_u32 s67, s67, 1
  s_cmp_ge_u32 s67, 52
  s_cbranch_scc1 L_V2_entry
  s_cmp_lt_u32 s72, 12
  s_cbranch_scc1 L_xK2
L_xK2_ret:
  s_waitcnt vmcnt(12)
  v_dot2_f32_bf16 v24, v96, v8, 0
  v_dot2_f32_bf16 v25, v100, v8, 0
  v_dot2_f32_bf16 v26, v104, v8, 0
  v_dot2_f32_bf16 v27, v108, v8, 0
  v_dot2_f32_bf16 v24, v97, v9, v24
  v_dot2_f32_bf16 v25, v101, v9, v25
  v_dot2_f32_bf16 v26, v105, v9, v26
  v_dot2_f32_bf16 v27, v109, v9, v27
  v_dot2_f32_bf16 v24, v98, v10, v24
  v_dot2_f32_bf16 v25, v102, v10, v25
  v_dot2_f32_bf16 v26, v106, v10, v26
  v_dot2_f32_bf16 v27, v110, v10, v27
  v_dot2_f32_bf16 v24, v99, v11, v24
  v_dot2_f32_bf16 v25, v103, v11, v25
  v_dot2_f32_bf16 v26, v107, v11, v26
  v_dot2_f32_bf16 v27, v111, v11, v27
  s_cmp_lt_u32 s66, 52
  s_cbranch_scc0 L_kd_K2
  s_mul_i32 s69, s66, 16384
  s_add_u32 s69, s69, s64
  s_add_u32 s66, s66, 1
L_kld_K2:
  buffer_load_dwordx4 v[96:99], v2, s[48:51], s69 offen offset:0 nt
  buffer_load_dwordx4 v[100:103], v2, s[48:51], s69 offen offset:1024 nt
  buffer_load_dwordx4 v[104:107], v2, s[48:51], s69 offen offset:2048 nt
  buffer_load_dwordx4 v[108:111], v2, s[48:51], s69 offen offset:3072 nt
  v_add_f32_dpp v24, v24, v24 quad_perm:[1,0,3,2] row_mask:0xf bank_mask:0xf
  v_add_f32_dpp v25, v25, v25 quad_perm:[1,0,3,2] row_mask:0xf bank_mask:0xf
  v_add_f32_dpp v26, v26, v26 quad_perm:[1,0,3,2] row_mask:0xf bank_mask:0xf
  v_add_f32_dpp v27, v27, v27 quad_perm:[1,0,3,2] row_mask:0xf bank_mask:0xf
  v_add_f32_dpp v24, v24, v24 quad_perm:[2,3,0,1] row_mask:0xf bank_mask:0xf
  v_add_f32_dpp v25, v25, v25 quad_perm:[2,3,0,1] row_mask:0xf bank_mask:0xf
  v_add_f32_dpp v26, v26, v26 quad_perm:[2,3,0,1] row_mask:0xf bank_mask:0xf
  v_add_f32_dpp v27, v27, v27 quad_perm:[2,3,0,1] row_mask:0xf bank_mask:0xf
  v_add_f32_dpp v24, v24, v24 row_half_mirror row_mask:0xf bank_mask:0xf
  v_add_f32_dpp v25, v25, v25 row_half_mirror row_mask:0xf bank_mask:0xf
  v_add_f32_dpp v26, v26, v26 row_half_mirror row_mask:0xf bank_mask:0xf
  v_add_f32_dpp v27, v27, v27 row_half_mirror row_mask:0xf bank_mask:0xf
  v_add_f32_dpp v24, v24, v24 row_mirror row_mask:0xf bank_mask:0xf
  v_add_f32_dpp v25, v25, v25 row_mirror row_mask:0xf bank_mask:0xf
  v_add_f32_dpp v26, v26, v26 row_mirror row_mask:0xf bank_mask:0xf
  v_add_f32_dpp v27, v27, v27 row_mirror row_mask:0xf bank_mask:0xf
  v_cvt_pk_bf16_f32 v28, v24, v25
  v_cvt_pk_bf16_f32 v29, v26, v27
  v_lshlrev_b32 v24, 16, v28
  v_and_b32 v25, s46, v28
  v_lshlrev_b32 v26, 16, v29
  v_and_b32 v27, s46, v29
  v_mul_f32 v24, s82, v24
  v_mul_f32 v25, s82, v25
  v_mul_f32 v26, s82, v26
  v_mul_f32 v27, s82, v27
  v_cvt_pk_bf16_f32 v28, v24, v25
  v_cvt_pk_bf16_f32 v29, v26, v27
  v_lshlrev_b32 v24, 16, v28
  v_and_b32 v25, s46, v28
  v_lshlrev_b32 v26, 16, v29
  v_and_b32 v27, s46, v29
  s_lshl_b32 s76, s67, 6
  v_add_u32 v36, s76, v7
  s_mov_b32 exec_lo, 0x00010001
  s_mov_b32 exec_hi, 0x00010001
  ds_write_b128 v36, v[24:27]
  s_mov_b64 exec, -1
  s_add_u32 s67, s67, 1
  s_cmp_ge_u32 s67, 52
  s_cbranch_scc1 L_V3_entry
  s_cmp_lt_u32 s72, 12
  s_cbranch_scc1 L_xK3
L_xK3_ret:
  s_waitcnt vmcnt(12)
  v_dot2_f32_bf16 v24, v112, v8, 0
  v_dot2_f32_bf16 v25, v116, v8, 0
  v_dot2_f32_bf16 v26, v120, v8, 0
  v_dot2_f32_bf16 v27, v124, v8, 0
  v_dot2_f32_bf16 v24, v113, v9, v24
  v_dot2_f32_bf16 v25, v117, v9, v25
  v_dot2_f32_bf16 v26, v121, v9, v26
  v_dot2_f32_bf16 v27, v125, v9, v27
  v_dot2_f32_bf16 v24, v114, v10, v24
  v_dot2_f32_bf16 v25, v118, v10, v25
  v_dot2_f32_bf16 v26, v122, v10, v26
  v_dot2_f32_bf16 v27, v126, v10, v27
  v_dot2_f32_bf16 v24, v115, v11, v24
  v_dot2_f32_bf16 v25, v119, v11, v25
  v_dot2_f32_bf16 v26, v123, v11, v26
  v_dot2_f32_bf16 v27, v127, v11, v27
  s_cmp_lt_u32 s66, 52
  s_cbranch_scc0 L_kd_K3
  s_mul_i32 s69, s66, 16384
  s_add_u32 s69, s69, s64
  s_add_u32 s66, s66, 1
L_kld_K3:
  buffer_load_dwordx4 v[112:115], v2, s[48:51], s69 offen offset:0 nt
  buffer_load_dwordx4 v[116:119], v2, s[48:51], s69 offen offset:1024 nt
  buffer_load_dwordx4 v[120:123], v2, s[48:51], s69 offen offset:2048 nt
  buffer_load_dwordx4 v[124:127], v2, s[48:51], s69 offen offset:3072 nt
  v_add_f32_dpp v24, v24, v24 quad_perm:[1,0,3,2] row_mask:0xf bank_mask:0xf
  v_add_f32_dpp v25, v25, v25 quad_perm:[1,0,3,2] row_mask:0xf bank_mask:0xf
  v_add_f32_dpp v26, v26, v26 quad_perm:[1,0,3,2] row_mask:0xf bank_mask:0xf
  v_add_f32_dpp v27, v27, v27 quad_perm:[1,0,3,2] row_mask:0xf bank_mask:0xf
  v_add_f32_dpp v24, v24, v24 quad_perm:[2,3,0,1] row_mask:0xf bank_mask:0xf
  v_add_f32_dpp v25, v25, v25 quad_perm:[2,3,0,1] row_mask:0xf bank_mask:0xf
  v_add_f32_dpp v26, v26, v26 quad_perm:[2,3,0,1] row_mask:0xf bank_mask:0xf
  v_add_f32_dpp v27, v27, v27 quad_perm:[2,3,0,1] row_mask:0xf bank_mask:0xf
  v_add_f32_dpp v24, v24, v24 row_half_mirror row_mask:0xf bank_mask:0xf
  v_add_f32_dpp v25, v25, v25 row_half_mirror row_mask:0xf bank_mask:0xf
  v_add_f32_dpp v26, v26, v26 row_half_mirror row_mask:0xf bank_mask:0xf
  v_add_f32_dpp v27, v27, v27 row_half_mirror row_mask:0xf bank_mask:0xf
  v_add_f32_dpp v24, v24, v24 row_mirror row_mask:0xf bank_mask:0xf
  v_add_f32_dpp v25, v25, v25 row_mirror row_mask:0xf bank_mask:0xf
  v_add_f32_dpp v26, v26, v26 row_mirror row_mask:0xf bank_mask:0xf
  v_add_f32_dpp v27, v27, v27 row_mirror row_mask:0xf bank_mask:0xf
  v_cvt_pk_bf16_f32 v28, v24, v25
  v_cvt_pk_bf16_f32 v29, v26, v27
  v_lshlrev_b32 v24, 16, v28
  v_and_b32 v25, s46, v28
  v_lshlrev_b32 v26, 16, v29
  v_and_b32 v27, s46, v29
  v_mul_f32 v24, s82, v24
  v_mul_f32 v25, s82, v25
  v_mul_f32 v26, s82, v26
  v_mul_f32 v27, s82, v27
  v_cvt_pk_bf16_f32 v28, v24, v25
  v_cvt_pk_bf16_f32 v29, v26, v27
  v_lshlrev_b32 v24, 16, v28
  v_and_b32 v25, s46, v28
  v_lshlrev_b32 v26, 16, v29
  v_and_b32 v27, s46, v29
  s_lshl_b32 s76, s67, 6
  v_add_u32 v36, s76, v7
  s_mov_b32 exec_lo, 0x00010001
  s_mov_b32 exec_hi, 0x00010001
  ds_write_b128 v36, v[24:27]
  s_mov_b64 exec, -1
  s_add_u32 s67, s67, 1
  s_cmp_ge_u32 s67, 52
  s_cbranch_scc1 L_V0_entry
  s_branch L_kloop
L_vloop:
L_V0_entry:
  s_waitcnt vmcnt(12) lgkmcnt(0)
  v_max3_f32 v23, v40, v41, v42
  v_max_f32 v23, v23, v43
  v_mul_f32 v23, s47, v23
  v_max_f32 v23, v23, v20
  v_sub_f32 v22, v20, v23
  v_fma_f32 v40, v40, s47, -v23
  v_fma_f32 v41, v41, s47, -v23
  v_fma_f32 v42, v42, s47, -v23
  v_fma_f32 v43, v43, s47, -v23
  v_exp_f32 v22, v22
  v_exp_f32 v40, v40
  v_exp_f32 v41, v41
  v_exp_f32 v42, v42
  v_exp_f32 v43, v43
  v_mov_b32 v20, v23
  v_fma_f32 v21, v21, v22, v40
  v_add_f32 v28, v41, v42
  v_add_f32 v21, v21, v43
  v_add_f32 v21, v21, v28
  v_pk_mul_f32 v[12:13], v[12:13], v[22:23] op_sel_hi:[1,0]
  v_pk_mul_f32 v[14:15], v[14:15], v[22:23] op_sel_hi:[1,0]
  v_pk_mul_f32 v[16:17], v[16:17], v[22:23] op_sel_hi:[1,0]
  v_pk_mul_f32 v[18:19], v[18:19], v[22:23] op_sel_hi:[1,0]
  v_lshlrev_b32 v28, 16, v64
  v_and_b32 v29, s46, v64
  v_lshlrev_b32 v30, 16, v65
  v_and_b32 v31, s46, v65
  v_lshlrev_b32 v32, 16, v66
  v_and_b32 v33, s46, v66
  v_lshlrev_b32 v34, 16, v67
  v_and_b32 v35, s46, v67
  v_pk_fma_f32 v[12:13], v[28:29], v[40:41], v[12:13] op_sel_hi:[1,0,1]
  v_pk_fma_f32 v[14:15], v[30:31], v[40:41], v[14:15] op_sel_hi:[1,0,1]
  v_pk_fma_f32 v[16:17], v[32:33], v[40:41], v[16:17] op_sel_hi:[1,0,1]
  v_pk_fma_f32 v[18:19], v[34:35], v[40:41], v[18:19] op_sel_hi:[1,0,1]
  v_lshlrev_b32 v28, 16, v68
  v_and_b32 v29, s46, v68
  v_lshlrev_b32 v30, 16, v69
  v_and_b32 v31, s46, v69
  v_lshlrev_b32 v32, 16, v70
  v_and_b32 v33, s46, v70
  v_lshlrev_b32 v34, 16, v71
  v_and_b32 v35, s46, v71
  v_pk_fma_f32 v[12:13], v[28:29], v[40:41], v[12:13] op_sel:[0,1,0] op_sel_hi:[1,1,1]
  v_pk_fma_f32 v[14:15], v[30:31], v[40:41], v[14:15] op_sel:[0,1,0] op_sel_hi:[1,1,1]
  v_pk_fma_f32 v[16:17], v[32:33], v[40:41], v[16:17] op_sel:[0,1,0] op_sel_hi:[1,1,1]
  v_pk_fma_f32 v[18:19], v[34:35], v[40:41], v[18:19] op_sel:[0,1,0] op_sel_hi:[1,1,1]
  v_lshlrev_b32 v28, 16, v72
  v_and_b32 v29, s46, v72
  v_lshlrev_b32 v30, 16, v73
  v_and_b32 v31, s46, v73
  v_lshlrev_b32 v32, 16, v74
  v_and_b32 v33, s46, v74
  v_lshlrev_b32 v34, 16, v75
  v_and_b32 v35, s46, v75
  v_pk_fma_f32 v[12:13], v[28:29], v[42:43], v[12:13] op_sel_hi:[1,0,1]
  v_pk_fma_f32 v[14:15], v[30:31], v[42:43], v[14:15] op_sel_hi:[1,0,1]
  v_pk_fma_f32 v[16:17], v[32:33], v[42:43], v[16:17] op_sel_hi:[1,0,1]
  v_pk_fma_f32 v[18:19], v[34:35], v[42:43], v[18:19] op_sel_hi:[1,0,1]
  v_lshlrev_b32 v28, 16, v76
  v_and_b32 v29, s46, v76
  v_lshlrev_b32 v30, 16, v77
  v_and_b32 v31, s46, v77
  v_lshlrev_b32 v32, 16, v78
  v_and_b32 v33, s46, v78
  v_lshlrev_b32 v34, 16, v79
  v_and_b32 v35, s46, v79
  v_pk_fma_f32 v[12:13], v[28:29], v[42:43], v[12:13] op_sel:[0,1,0] op_sel_hi:[1,1,1]
  v_pk_fma_f32 v[14:15], v[30:31], v[42:43], v[14:15] op_sel:[0,1,0] op_sel_hi:[1,1,1]
  v_pk_fma_f32 v[16:17], v[32:33], v[42:43], v[16:17] op_sel:[0,1,0] op_sel_hi:[1,1,1]
  v_pk_fma_f32 v[18:19], v[34:35], v[42:43], v[18:19] op_sel:[0,1,0] op_sel_hi:[1,1,1]
  s_cmp_lt_u32 s5, 52
  s_cbranch_scc0 L_vd_V0
  s_mul_i32 s69, s5, 16384
  s_add_u32 s69, s69, s64
  s_lshl_b32 s76, s5, 6
  v_add_u32 v36, s76, v7
  ds_read_b128 v[40:43], v36
  s_lshr_b32 s79, s44, 1
  s_add_u32 s5, s5, 1
  s_cmp_le_u32 s5, 48
  s_cbranch_scc1 L_vld_V0
  v_mov_b32 v56, 1
  s_mov_b64 exec, 1
  buffer_atomic_add v56, v60, s[56:59], 0 offen sc0
  s_mov_b64 exec, -1
L_vld_V0:
  buffer_load_dwordx4 v[64:67], v2, s[48:51], s69 offen offset:0 nt
  buffer_load_dwordx4 v[68:71], v2, s[48:51], s69 offen offset:1024 nt
  buffer_load_dwordx4 v[72:75], v2, s[48:51], s69 offen offset:2048 nt
  buffer_load_dwordx4 v[76:79], v2, s[48:51], s69 offen offset:3072 nt
  s_add_u32 s67, s67, 1
  s_cmp_ge_u32 s67, 104
  s_cbranch_scc1 L_D1_entry
L_V1_entry:
  s_waitcnt vmcnt(12) lgkmcnt(0)
  v_max3_f32 v23, v44, v45, v46
  v_max_f32 v23, v23, v47
  v_mul_f32 v23, s47, v23
  v_max_f32 v23, v23, v20
  v_sub_f32 v22, v20, v23
  v_fma_f32 v44, v44, s47, -v23
  v_fma_f32 v45, v45, s47, -v23
  v_fma_f32 v46, v46, s47, -v23
  v_fma_f32 v47, v47, s47, -v23
  v_exp_f32 v22, v22
  v_exp_f32 v44, v44
  v_exp_f32 v45, v45
  v_exp_f32 v46, v46
  v_exp_f32 v47, v47
  v_mov_b32 v20, v23
  v_fma_f32 v21, v21, v22, v44
  v_add_f32 v28, v45, v46
  v_add_f32 v21, v21, v47
  v_add_f32 v21, v21, v28
  v_pk_mul_f32 v[12:13], v[12:13], v[22:23] op_sel_hi:[1,0]
  v_pk_mul_f32 v[14:15], v[14:15], v[22:23] op_sel_hi:[1,0]
  v_pk_mul_f32 v[16:17], v[16:17], v[22:23] op_sel_hi:[1,0]
  v_pk_mul_f32 v[18:19], v[18:19], v[22:23] op_sel_hi:[1,0]
  v_lshlrev_b32 v28, 16, v80
  v_and_b32 v29, s46, v80
  v_lshlrev_b32 v30, 16, v81
  v_and_b32 v31, s46, v81
  v_lshlrev_b32 v32, 16, v82
  v_and_b32 v33, s46, v82
  v_lshlrev_b32 v34, 16, v83
  v_and_b32 v35, s46, v83
  v_pk_fma_f32 v[12:13], v[28:29], v[44:45], v[12:13] op_sel_hi:[1,0,1]
  v_pk_fma_f32 v[14:15], v[30:31], v[44:45], v[14:15] op_sel_hi:[1,0,1]
  v_pk_fma_f32 v[16:17], v[32:33], v[44:45], v[16:17] op_sel_hi:[1,0,1]
  v_pk_fma_f32 v[18:19], v[34:35], v[44:45], v[18:19] op_sel_hi:[1,0,1]
  v_lshlrev_b32 v28, 16, v84
  v_and_b32 v29, s46, v84
  v_lshlrev_b32 v30, 16, v85
  v_and_b32 v31, s46, v85
  v_lshlrev_b32 v32, 16, v86
  v_and_b32 v33, s46, v86
  v_lshlrev_b32 v34, 16, v87
  v_and_b32 v35, s46, v87
  v_pk_fma_f32 v[12:13], v[28:29], v[44:45], v[12:13] op_sel:[0,1,0] op_sel_hi:[1,1,1]
  v_pk_fma_f32 v[14:15], v[30:31], v[44:45], v[14:15] op_sel:[0,1,0] op_sel_hi:[1,1,1]
  v_pk_fma_f32 v[16:17], v[32:33], v[44:45], v[16:17] op_sel:[0,1,0] op_sel_hi:[1,1,1]
  v_pk_fma_f32 v[18:19], v[34:35], v[44:45], v[18:19] op_sel:[0,1,0] op_sel_hi:[1,1,1]
  v_lshlrev_b32 v28, 16, v88
  v_and_b32 v29, s46, v88
  v_lshlrev_b32 v30, 16, v89
  v_and_b32 v31, s46, v89
  v_lshlrev_b32 v32, 16, v90
  v_and_b32 v33, s46, v90
  v_lshlrev_b32 v34, 16, v91
  v_and_b32 v35, s46, v91
  v_pk_fma_f32 v[12:13], v[28:29], v[46:47], v[12:13] op_sel_hi:[1,0,1]
  v_pk_fma_f32 v[14:15], v[30:31], v[46:47], v[14:15] op_sel_hi:[1,0,1]
  v_pk_fma_f32 v[16:17], v[32:33], v[46:47], v[16:17] op_sel_hi:[1,0,1]
  v_pk_fma_f32 v[18:19], v[34:35], v[46:47], v[18:19] op_sel_hi:[1,0,1]
  v_lshlrev_b32 v28, 16, v92
  v_and_b32 v29, s46, v92
  v_lshlrev_b32 v30, 16, v93
  v_and_b32 v31, s46, v93
  v_lshlrev_b32 v32, 16, v94
  v_and_b32 v33, s46, v94
  v_lshlrev_b32 v34, 16, v95
  v_and_b32 v35, s46, v95
  v_pk_fma_f32 v[12:13], v[28:29], v[46:47], v[12:13] op_sel:[0,1,0] op_sel_hi:[1,1,1]
  v_pk_fma_f32 v[14:15], v[30:31], v[46:47], v[14:15] op_sel:[0,1,0] op_sel_hi:[1,1,1]
  v_pk_fma_f32 v[16:17], v[32:33], v[46:47], v[16:17] op_sel:[0,1,0] op_sel_hi:[1,1,1]
  v_pk_fma_f32 v[18:19], v[34:35], v[46:47], v[18:19] op_sel:[0,1,0] op_sel_hi:[1,1,1]
  s_cmp_lt_u32 s5, 52
  s_cbranch_scc0 L_vd_V1
  s_mul_i32 s69, s5, 16384
  s_add_u32 s69, s69, s64
  s_lshl_b32 s76, s5, 6
  v_add_u32 v36, s76, v7
  ds_read_b128 v[44:47], v36
  s_lshr_b32 s79, s44, 1
  s_add_u32 s5, s5, 1
L_vld_V1:
  buffer_load_dwordx4 v[80:83], v2, s[48:51], s69 offen offset:0 nt
  buffer_load_dwordx4 v[84:87], v2, s[48:51], s69 offen offset:1024 nt
  buffer_load_dwordx4 v[88:91], v2, s[48:51], s69 offen offset:2048 nt
  buffer_load_dwordx4 v[92:95], v2, s[48:51], s69 offen offset:3072 nt
  s_add_u32 s67, s67, 1
  s_cmp_ge_u32 s67, 104
  s_cbranch_scc1 L_D2_entry
L_V2_entry:
  s_waitcnt vmcnt(12) lgkmcnt(0)
  v_max3_f32 v23, v48, v49, v50
  v_max_f32 v23, v23, v51
  v_mul_f32 v23, s47, v23
  v_max_f32 v23, v23, v20
  v_sub_f32 v22, v20, v23
  v_fma_f32 v48, v48, s47, -v23
  v_fma_f32 v49, v49, s47, -v23
  v_fma_f32 v50, v50, s47, -v23
  v_fma_f32 v51, v51, s47, -v23
  v_exp_f32 v22, v22
  v_exp_f32 v48, v48
  v_exp_f32 v49, v49
  v_exp_f32 v50, v50
  v_exp_f32 v51, v51
  v_mov_b32 v20, v23
  v_fma_f32 v21, v21, v22, v48
  v_add_f32 v28, v49, v50
  v_add_f32 v21, v21, v51
  v_add_f32 v21, v21, v28
  v_pk_mul_f32 v[12:13], v[12:13], v[22:23] op_sel_hi:[1,0]
  v_pk_mul_f32 v[14:15], v[14:15], v[22:23] op_sel_hi:[1,0]
  v_pk_mul_f32 v[16:17], v[16:17], v[22:23] op_sel_hi:[1,0]
  v_pk_mul_f32 v[18:19], v[18:19], v[22:23] op_sel_hi:[1,0]
  v_lshlrev_b32 v28, 16, v96
  v_and_b32 v29, s46, v96
  v_lshlrev_b32 v30, 16, v97
  v_and_b32 v31, s46, v97
  v_lshlrev_b32 v32, 16, v98
  v_and_b32 v33, s46, v98
  v_lshlrev_b32 v34, 16, v99
  v_and_b32 v35, s46, v99
  v_pk_fma_f32 v[12:13], v[28:29], v[48:49], v[12:13] op_sel_hi:[1,0,1]
  v_pk_fma_f32 v[14:15], v[30:31], v[48:49], v[14:15] op_sel_hi:[1,0,1]
  v_pk_fma_f32 v[16:17], v[32:33], v[48:49], v[16:17] op_sel_hi:[1,0,1]
  v_pk_fma_f32 v[18:19], v[34:35], v[48:49], v[18:19] op_sel_hi:[1,0,1]
  v_lshlrev_b32 v28, 16, v100
  v_and_b32 v29, s46, v100
  v_lshlrev_b32 v30, 16, v101
  v_and_b32 v31, s46, v101
  v_lshlrev_b32 v32, 16, v102
  v_and_b32 v33, s46, v102
  v_lshlrev_b32 v34, 16, v103
  v_and_b32 v35, s46, v103
  v_pk_fma_f32 v[12:13], v[28:29], v[48:49], v[12:13] op_sel:[0,1,0] op_sel_hi:[1,1,1]
  v_pk_fma_f32 v[14:15], v[30:31], v[48:49], v[14:15] op_sel:[0,1,0] op_sel_hi:[1,1,1]
  v_pk_fma_f32 v[16:17], v[32:33], v[48:49], v[16:17] op_sel:[0,1,0] op_sel_hi:[1,1,1]
  v_pk_fma_f32 v[18:19], v[34:35], v[48:49], v[18:19] op_sel:[0,1,0] op_sel_hi:[1,1,1]
  v_lshlrev_b32 v28, 16, v104
  v_and_b32 v29, s46, v104
  v_lshlrev_b32 v30, 16, v105
  v_and_b32 v31, s46, v105
  v_lshlrev_b32 v32, 16, v106
  v_and_b32 v33, s46, v106
  v_lshlrev_b32 v34, 16, v107
  v_and_b32 v35, s46, v107
  v_pk_fma_f32 v[12:13], v[28:29], v[50:51], v[12:13] op_sel_hi:[1,0,1]
  v_pk_fma_f32 v[14:15], v[30:31], v[50:51], v[14:15] op_sel_hi:[1,0,1]
  v_pk_fma_f32 v[16:17], v[32:33], v[50:51], v[16:17] op_sel_hi:[1,0,1]
  v_pk_fma_f32 v[18:19], v[34:35], v[50:51], v[18:19] op_sel_hi:[1,0,1]
  v_lshlrev_b32 v28, 16, v108
  v_and_b32 v29, s46, v108
  v_lshlrev_b32 v30, 16, v109
  v_and_b32 v31, s46, v109
  v_lshlrev_b32 v32, 16, v110
  v_and_b32 v33, s46, v110
  v_lshlrev_b32 v34, 16, v111
  v_and_b32 v35, s46, v111
  v_pk_fma_f32 v[12:13], v[28:29], v[50:51], v[12:13] op_sel:[0,1,0] op_sel_hi:[1,1,1]
  v_pk_fma_f32 v[14:15], v[30:31], v[50:51], v[14:15] op_sel:[0,1,0] op_sel_hi:[1,1,1]
  v_pk_fma_f32 v[16:17], v[32:33], v[50:51], v[16:17] op_sel:[0,1,0] op_sel_hi:[1,1,1]
  v_pk_fma_f32 v[18:19], v[34:35], v[50:51], v[18:19] op_sel:[0,1,0] op_sel_hi:[1,1,1]
  s_cmp_lt_u32 s5, 52
  s_cbranch_scc0 L_vd_V2
  s_mul_i32 s69, s5, 16384
  s_add_u32 s69, s69, s64
  s_lshl_b32 s76, s5, 6
  v_add_u32 v36, s76, v7
  ds_read_b128 v[48:51], v36
  s_lshr_b32 s79, s44, 1
  s_add_u32 s5, s5, 1
  s_cmp_le_u32 s5, 48
  s_cbranch_scc1 L_vld_V2
  v_mov_b32 v58, 1
  s_mov_b64 exec, 1
  buffer_atomic_add v58, v60, s[56:59], 0 offen sc0
  s_mov_b64 exec, -1
L_vld_V2:
  buffer_load_dwordx4 v[96:99], v2, s[48:51], s69 offen offset:0 nt
  buffer_load_dwordx4 v[100:103], v2, s[48:51], s69 offen offset:1024 nt
  buffer_load_dwordx4 v[104:107], v2, s[48:51], s69 offen offset:2048 nt
  buffer_load_dwordx4 v[108:111], v2, s[48:51], s69 offen offset:3072 nt
  s_add_u32 s67, s67, 1
  s_cmp_ge_u32 s67, 104
  s_cbranch_scc1 L_D3_entry
L_V3_entry:
  s_waitcnt vmcnt(12) lgkmcnt(0)
  v_max3_f32 v23, v52, v53, v54
  v_max_f32 v23, v23, v55
  v_mul_f32 v23, s47, v23
  v_max_f32 v23, v23, v20
  v_sub_f32 v22, v20, v23
  v_fma_f32 v52, v52, s47, -v23
  v_fma_f32 v53, v53, s47, -v23
  v_fma_f32 v54, v54, s47, -v23
  v_fma_f32 v55, v55, s47, -v23
  v_exp_f32 v22, v22
  v_exp_f32 v52, v52
  v_exp_f32 v53, v53
  v_exp_f32 v54, v54
  v_exp_f32 v55, v55
  v_mov_b32 v20, v23
  v_fma_f32 v21, v21, v22, v52
  v_add_f32 v28, v53, v54
  v_add_f32 v21, v21, v55
  v_add_f32 v21, v21, v28
  v_pk_mul_f32 v[12:13], v[12:13], v[22:23] op_sel_hi:[1,0]
  v_pk_mul_f32 v[14:15], v[14:15], v[22:23] op_sel_hi:[1,0]
  v_pk_mul_f32 v[16:17], v[16:17], v[22:23] op_sel_hi:[1,0]
  v_pk_mul_f32 v[18:19], v[18:19], v[22:23] op_sel_hi:[1,0]
  v_lshlrev_b32 v28, 16, v112
  v_and_b32 v29, s46, v112
  v_lshlrev_b32 v30, 16, v113
  v_and_b32 v31, s46, v113
  v_lshlrev_b32 v32, 16, v114
  v_and_b32 v33, s46, v114
  v_lshlrev_b32 v34, 16, v115
  v_and_b32 v35, s46, v115
  v_pk_fma_f32 v[12:13], v[28:29], v[52:53], v[12:13] op_sel_hi:[1,0,1]
  v_pk_fma_f32 v[14:15], v[30:31], v[52:53], v[14:15] op_sel_hi:[1,0,1]
  v_pk_fma_f32 v[16:17], v[32:33], v[52:53], v[16:17] op_sel_hi:[1,0,1]
  v_pk_fma_f32 v[18:19], v[34:35], v[52:53], v[18:19] op_sel_hi:[1,0,1]
  v_lshlrev_b32 v28, 16, v116
  v_and_b32 v29, s46, v116
  v_lshlrev_b32 v30, 16, v117
  v_and_b32 v31, s46, v117
  v_lshlrev_b32 v32, 16, v118
  v_and_b32 v33, s46, v118
  v_lshlrev_b32 v34, 16, v119
  v_and_b32 v35, s46, v119
  v_pk_fma_f32 v[12:13], v[28:29], v[52:53], v[12:13] op_sel:[0,1,0] op_sel_hi:[1,1,1]
  v_pk_fma_f32 v[14:15], v[30:31], v[52:53], v[14:15] op_sel:[0,1,0] op_sel_hi:[1,1,1]
  v_pk_fma_f32 v[16:17], v[32:33], v[52:53], v[16:17] op_sel:[0,1,0] op_sel_hi:[1,1,1]
  v_pk_fma_f32 v[18:19], v[34:35], v[52:53], v[18:19] op_sel:[0,1,0] op_sel_hi:[1,1,1]
  v_lshlrev_b32 v28, 16, v120
  v_and_b32 v29, s46, v120
  v_lshlrev_b32 v30, 16, v121
  v_and_b32 v31, s46, v121
  v_lshlrev_b32 v32, 16, v122
  v_and_b32 v33, s46, v122
  v_lshlrev_b32 v34, 16, v123
  v_and_b32 v35, s46, v123
  v_pk_fma_f32 v[12:13], v[28:29], v[54:55], v[12:13] op_sel_hi:[1,0,1]
  v_pk_fma_f32 v[14:15], v[30:31], v[54:55], v[14:15] op_sel_hi:[1,0,1]
  v_pk_fma_f32 v[16:17], v[32:33], v[54:55], v[16:17] op_sel_hi:[1,0,1]
  v_pk_fma_f32 v[18:19], v[34:35], v[54:55], v[18:19] op_sel_hi:[1,0,1]
  v_lshlrev_b32 v28, 16, v124
  v_and_b32 v29, s46, v124
  v_lshlrev_b32 v30, 16, v125
  v_and_b32 v31, s46, v125
  v_lshlrev_b32 v32, 16, v126
  v_and_b32 v33, s46, v126
  v_lshlrev_b32 v34, 16, v127
  v_and_b32 v35, s46, v127
  v_pk_fma_f32 v[12:13], v[28:29], v[54:55], v[12:13] op_sel:[0,1,0] op_sel_hi:[1,1,1]
  v_pk_fma_f32 v[14:15], v[30:31], v[54:55], v[14:15] op_sel:[0,1,0] op_sel_hi:[1,1,1]
  v_pk_fma_f32 v[16:17], v[32:33], v[54:55], v[16:17] op_sel:[0,1,0] op_sel_hi:[1,1,1]
  v_pk_fma_f32 v[18:19], v[34:35], v[54:55], v[18:19] op_sel:[0,1,0] op_sel_hi:[1,1,1]
  s_cmp_lt_u32 s5, 52
  s_cbranch_scc0 L_vd_V3
  s_mul_i32 s69, s5, 16384
  s_add_u32 s69, s69, s64
  s_lshl_b32 s76, s5, 6
  v_add_u32 v36, s76, v7
  ds_read_b128 v[52:55], v36
  s_lshr_b32 s79, s44, 1
  s_add_u32 s5, s5, 1
L_vld_V3:
  buffer_load_dwordx4 v[112:115], v2, s[48:51], s69 offen offset:0 nt
  buffer_load_dwordx4 v[116:119], v2, s[48:51], s69 offen offset:1024 nt
  buffer_load_dwordx4 v[120:123], v2, s[48:51], s69 offen offset:2048 nt
  buffer_load_dwordx4 v[124:127], v2, s[48:51], s69 offen offset:3072 nt
  s_add_u32 s67, s67, 1
  s_cmp_ge_u32 s67, 104
  s_cbranch_scc1 L_D0_entry
  s_branch L_vloop
L_D0_entry:
  s_cmp_eq_u32 s53, 0
  s_cbranch_scc1 L_dinv_D0
  s_cmp_eq_u32 s73, s71
  s_cbranch_scc1 L_nq_D0
  s_mov_b32 s71, s73
  s_lshl_b32 s76, s71, 8
  v_add_u32 v36, s76, v6
  ds_read_b128 v[8:11], v36
  s_waitcnt lgkmcnt(0)
L_nq_D0:
  s_waitcnt vmcnt(12)
  v_dot2_f32_bf16 v24, v64, v8, 0
  v_dot2_f32_bf16 v25, v68, v8, 0
  v_dot2_f32_bf16 v26, v72, v8, 0
  v_dot2_f32_bf16 v27, v76, v8, 0
  v_dot2_f32_bf16 v24, v65, v9, v24
  v_dot2_f32_bf16 v25, v69, v9, v25
  v_dot2_f32_bf16 v26, v73, v9, v26
  v_dot2_f32_bf16 v27, v77, v9, v27
  v_dot2_f32_bf16 v24, v66, v10, v24
  v_dot2_f32_bf16 v25, v70, v10, v25
  v_dot2_f32_bf16 v26, v74, v10, v26
  v_dot2_f32_bf16 v27, v78, v10, v27
  v_dot2_f32_bf16 v24, v67, v11, v24
  v_dot2_f32_bf16 v25, v71, v11, v25
  v_dot2_f32_bf16 v26, v75, v11, v26
  v_dot2_f32_bf16 v27, v79, v11, v27
  s_mov_b32 s48, s18
  s_mov_b32 s49, s19
  s_mov_b32 s78, 0
  s_mov_b32 s11, 0
  s_cmp_lg_u32 s68, 0
  s_cbranch_scc1 L_nx_D0
  v_readfirstlane_b32 s77, v56
  s_nop 1
  s_cmp_lt_u32 s77, 384
  s_cbranch_scc0 L_ne_D0
  s_mul_i32 s76, s77, 1366
  s_lshr_b32 s76, s76, 16
  s_mul_i32 s69, s76, 48
  s_sub_u32 s69, s77, s69
  s_lshl_b32 s69, s69, 12
  s_add_u32 s69, s69, 851968
  s_add_u32 s69, s69, s65
  s_lshr_b32 s79, s76, 1
  s_and_b32 s76, s76, 1
  s_lshl_b32 s76, s76, 20
  s_add_u32 s69, s69, s76
  s_lshl_b32 s76, s79, 26
  s_add_u32 s69, s69, s76
  s_mov_b32 s9, s69
  s_mov_b32 s10, s79
  s_mov_b32 s11, 1
  s_mov_b32 s78, 1
  v_mov_b32 v56, 1
  s_mov_b64 exec, 1
  buffer_atomic_add v56, v60, s[56:59], 0 offen sc0
  s_mov_b64 exec, -1
  s_branch L_nd_D0
L_ne_D0:
  s_mov_b32 s68, 1
L_nx_D0:
  s_mov_b32 s69, 0x7ff00000
  s_mov_b32 s79, s70
L_nd_D0:
  buffer_load_dwordx4 v[64:67], v2, s[48:51], s69 offen offset:0 nt
  buffer_load_dwordx4 v[68:71], v2, s[48:51], s69 offen offset:1024 nt
  buffer_load_dwordx4 v[72:75], v2, s[48:51], s69 offen offset:2048 nt
  buffer_load_dwordx4 v[76:79], v2, s[48:51], s69 offen offset:3072 nt
  v_add_f32_dpp v24, v24, v24 quad_perm:[1,0,3,2] row_mask:0xf bank_mask:0xf
  v_add_f32_dpp v25, v25, v25 quad_perm:[1,0,3,2] row_mask:0xf bank_mask:0xf
  v_add_f32_dpp v26, v26, v26 quad_perm:[1,0,3,2] row_mask:0xf bank_mask:0xf
  v_add_f32_dpp v27, v27, v27 quad_perm:[1,0,3,2] row_mask:0xf bank_mask:0xf
  v_add_f32_dpp v24, v24, v24 quad_perm:[2,3,0,1] row_mask:0xf bank_mask:0xf
  v_add_f32_dpp v25, v25, v25 quad_perm:[2,3,0,1] row_mask:0xf bank_mask:0xf
  v_add_f32_dpp v26, v26, v26 quad_perm:[2,3,0,1] row_mask:0xf bank_mask:0xf
  v_add_f32_dpp v27, v27, v27 quad_perm:[2,3,0,1] row_mask:0xf bank_mask:0xf
  v_add_f32_dpp v24, v24, v24 row_half_mirror row_mask:0xf bank_mask:0xf
  v_add_f32_dpp v25, v25, v25 row_half_mirror row_mask:0xf bank_mask:0xf
  v_add_f32_dpp v26, v26, v26 row_half_mirror row_mask:0xf bank_mask:0xf
  v_add_f32_dpp v27, v27, v27 row_half_mirror row_mask:0xf bank_mask:0xf
  v_add_f32_dpp v24, v24, v24 row_mirror row_mask:0xf bank_mask:0xf
  v_add_f32_dpp v25, v25, v25 row_mirror row_mask:0xf bank_mask:0xf
  v_add_f32_dpp v26, v26, v26 row_mirror row_mask:0xf bank_mask:0xf
  v_add_f32_dpp v27, v27, v27 row_mirror row_mask:0xf bank_mask:0xf
  v_cvt_pk_bf16_f32 v28, v24, v25
  v_cvt_pk_bf16_f32 v29, v26, v27
  v_lshlrev_b32 v24, 16, v28
  v_and_b32 v25, s46, v28
  v_lshlrev_b32 v26, 16, v29
  v_and_b32 v27, s46, v29
  v_mul_f32 v24, s82, v24
  v_mul_f32 v25, s82, v25
  v_mul_f32 v26, s82, v26
  v_mul_f32 v27, s82, v27
  v_cvt_pk_bf16_f32 v28, v24, v25
  v_cvt_pk_bf16_f32 v29, v26, v27
  v_lshlrev_b32 v24, 16, v28
  v_and_b32 v25, s46, v28
  v_lshlrev_b32 v26, 16, v29
  v_and_b32 v27, s46, v29
  s_mov_b32 s73, s79
  s_mov_b32 s53, s78
  s_add_u32 s67, s67, 1
L_D1_entry:
  s_cmp_eq_u32 s54, 0
  s_cbranch_scc1 L_dinv_D1
  s_cmp_eq_u32 s74, s70
  s_cbranch_scc1 L_nosw_D1
  s_mov_b32 s12, s74
  s_call_b64 s[80:81], L_switch
L_nosw_D1:
  v_max3_f32 v23, v24, v25, v26
  v_max_f32 v23, v23, v27
  v_mul_f32 v23, s47, v23
  v_max_f32 v23, v23, v20
  v_sub_f32 v22, v20, v23
  v_fma_f32 v24, v24, s47, -v23
  v_fma_f32 v25, v25, s47, -v23
  v_fma_f32 v26, v26, s47, -v23
  v_fma_f32 v27, v27, s47, -v23
  v_exp_f32 v22, v22
  v_exp_f32 v24, v24
  v_exp_f32 v25, v25
  v_exp_f32 v26, v26
  v_exp_f32 v27, v27
  v_mov_b32 v20, v23
  v_fma_f32 v21, v21, v22, v24
  v_add_f32 v28, v25, v26
  v_add_f32 v21, v21, v27
  v_add_f32 v21, v21, v28
  v_pk_mul_f32 v[12:13], v[12:13], v[22:23] op_sel_hi:[1,0]
  v_pk_mul_f32 v[14:15], v[14:15], v[22:23] op_sel_hi:[1,0]
  v_pk_mul_f32 v[16:17], v[16:17], v[22:23] op_sel_hi:[1,0]
  v_pk_mul_f32 v[18:19], v[18:19], v[22:23] op_sel_hi:[1,0]
  s_waitcnt vmcnt(12)
  v_lshlrev_b32 v28, 16, v80
  v_and_b32 v29, s46, v80
  v_lshlrev_b32 v30, 16, v81
  v_and_b32 v31, s46, v81
  v_lshlrev_b32 v32, 16, v82
  v_and_b32 v33, s46, v82
  v_lshlrev_b32 v34, 16, v83
  v_and_b32 v35, s46, v83
  v_pk_fma_f32 v[12:13], v[28:29], v[24:25], v[12:13] op_sel_hi:[1,0,1]
  v_pk_fma_f32 v[14:15], v[30:31], v[24:25], v[14:15] op_sel_hi:[1,0,1]
  v_pk_fma_f32 v[16:17], v[32:33], v[24:25], v[16:17] op_sel_hi:[1,0,1]
  v_pk_fma_f32 v[18:19], v[34:35], v[24:25], v[18:19] op_sel_hi:[1,0,1]
  v_lshlrev_b32 v28, 16, v84
  v_and_b32 v29, s46, v84
  v_lshlrev_b32 v30, 16, v85
  v_and_b32 v31, s46, v85
  v_lshlrev_b32 v32, 16, v86
  v_and_b32 v33, s46, v86
  v_lshlrev_b32 v34, 16, v87
  v_and_b32 v35, s46, v87
  v_pk_fma_f32 v[12:13], v[28:29], v[24:25], v[12:13] op_sel:[0,1,0] op_sel_hi:[1,1,1]
  v_pk_fma_f32 v[14:15], v[30:31], v[24:25], v[14:15] op_sel:[0,1,0] op_sel_hi:[1,1,1]
  v_pk_fma_f32 v[16:17], v[32:33], v[24:25], v[16:17] op_sel:[0,1,0] op_sel_hi:[1,1,1]
  v_pk_fma_f32 v[18:19], v[34:35], v[24:25], v[18:19] op_sel:[0,1,0] op_sel_hi:[1,1,1]
  v_lshlrev_b32 v28, 16, v88
  v_and_b32 v29, s46, v88
  v_lshlrev_b32 v30, 16, v89
  v_and_b32 v31, s46, v89
  v_lshlrev_b32 v32, 16, v90
  v_and_b32 v33, s46, v90
  v_lshlrev_b32 v34, 16, v91
  v_and_b32 v35, s46, v91
  v_pk_fma_f32 v[12:13], v[28:29], v[26:27], v[12:13] op_sel_hi:[1,0,1]
  v_pk_fma_f32 v[14:15], v[30:31], v[26:27], v[14:15] op_sel_hi:[1,0,1]
  v_pk_fma_f32 v[16:17], v[32:33], v[26:27], v[16:17] op_sel_hi:[1,0,1]
  v_pk_fma_f32 v[18:19], v[34:35], v[26:27], v[18:19] op_sel_hi:[1,0,1]
  v_lshlrev_b32 v28, 16, v92
  v_and_b32 v29, s46, v92
  v_lshlrev_b32 v30, 16, v93
  v_and_b32 v31, s46, v93
  v_lshlrev_b32 v32, 16, v94
  v_and_b32 v33, s46, v94
  v_lshlrev_b32 v34, 16, v95
  v_and_b32 v35, s46, v95
  v_pk_fma_f32 v[12:13], v[28:29], v[26:27], v[12:13] op_sel:[0,1,0] op_sel_hi:[1,1,1]
  v_pk_fma_f32 v[14:15], v[30:31], v[26:27], v[14:15] op_sel:[0,1,0] op_sel_hi:[1,1,1]
  v_pk_fma_f32 v[16:17], v[32:33], v[26:27], v[16:17] op_sel:[0,1,0] op_sel_hi:[1,1,1]
  v_pk_fma_f32 v[18:19], v[34:35], v[26:27], v[18:19] op_sel:[0,1,0] op_sel_hi:[1,1,1]
  s_mov_b32 s48, s20
  s_mov_b32 s49, s21
  s_mov_b32 s78, s11
  s_mov_b32 s79, s10
  s_cmp_eq_u32 s11, 1
  s_cselect_b32 s69, s9, 0x7ff00000
  buffer_load_dwordx4 v[80:83], v2, s[48:51], s69 offen offset:0 nt
  buffer_load_dwordx4 v[84:87], v2, s[48:51], s69 offen offset:1024 nt
  buffer_load_dwordx4 v[88:91], v2, s[48:51], s69 offen offset:2048 nt
  buffer_load_dwordx4 v[92:95], v2, s[48:51], s69 offen offset:3072 nt
  s_mov_b32 s74, s79
  s_mov_b32 s54, s78
  s_add_u32 s67, s67, 1
L_D2_entry:
  s_cmp_eq_u32 s55, 0
  s_cbranch_scc1 L_dinv_D2
  s_cmp_eq_u32 s75, s71
  s_cbranch_scc1 L_nq_D2
  s_mov_b32 s71, s75
  s_lshl_b32 s76, s71, 8
  v_add_u32 v36, s76, v6
  ds_read_b128 v[8:11], v36
  s_waitcnt lgkmcnt(0)
L_nq_D2:
  s_waitcnt vmcnt(12)
  v_dot2_f32_bf16 v24, v96, v8, 0
  v_dot2_f32_bf16 v25, v100, v8, 0
  v_dot2_f32_bf16 v26, v104, v8, 0
  v_dot2_f32_bf16 v27, v108, v8, 0
  v_dot2_f32_bf16 v24, v97, v9, v24
  v_dot2_f32_bf16 v25, v101, v9, v25
  v_dot2_f32_bf16 v26, v105, v9, v26
  v_dot2_f32_bf16 v27, v109, v9, v27
  v_dot2_f32_bf16 v24, v98, v10, v24
  v_dot2_f32_bf16 v25, v102, v10, v25
  v_dot2_f32_bf16 v26, v106, v10, v26
  v_dot2_f32_bf16 v27, v110, v10, v27
  v_dot2_f32_bf16 v24, v99, v11, v24
  v_dot2_f32_bf16 v25, v103, v11, v25
  v_dot2_f32_bf16 v26, v107, v11, v26
  v_dot2_f32_bf16 v27, v111, v11, v27
  s_mov_b32 s48, s18
  s_mov_b32 s49, s19
  s_mov_b32 s78, 0
  s_mov_b32 s11, 0
  s_cmp_lg_u32 s68, 0
  s_cbranch_scc1 L_nx_D2
  v_readfirstlane_b32 s77, v58
  s_nop 1
  s_cmp_lt_u32 s77, 384
  s_cbranch_scc0 L_ne_D2
  s_mul_i32 s76, s77, 1366
  s_lshr_b32 s76, s76, 16
  s_mul_i32 s69, s76, 48
  s_sub_u32 s69, s77, s69
  s_lshl_b32 s69, s69, 12
  s_add_u32 s69, s69, 851968
  s_add_u32 s69, s69, s65
  s_lshr_b32 s79, s76, 1
  s_and_b32 s76, s76, 1
  s_lshl_b32 s76, s76, 20
  s_add_u32 s69, s69, s76
  s_lshl_b32 s76, s79, 26
  s_add_u32 s69, s69, s76
  s_mov_b32 s9, s69
  s_mov_b32 s10, s79
  s_mov_b32 s11, 1
  s_mov_b32 s78, 1
  v_mov_b32 v58, 1
  s_mov_b64 exec, 1
  buffer_atomic_add v58, v60, s[56:59], 0 offen sc0
  s_mov_b64 exec, -1
  s_branch L_nd_D2
L_ne_D2:
  s_mov_b32 s68, 1
L_nx_D2:
  s_mov_b32 s69, 0x7ff00000
  s_mov_b32 s79, s70
L_nd_D2:
  buffer_load_dwordx4 v[96:99], v2, s[48:51], s69 offen offset:0 nt
  buffer_load_dwordx4 v[100:103], v2, s[48:51], s69 offen offset:1024 nt
  buffer_load_dwordx4 v[104:107], v2, s[48:51], s69 offen offset:2048 nt
  buffer_load_dwordx4 v[108:111], v2, s[48:51], s69 offen offset:3072 nt
  v_add_f32_dpp v24, v24, v24 quad_perm:[1,0,3,2] row_mask:0xf bank_mask:0xf
  v_add_f32_dpp v25, v25, v25 quad_perm:[1,0,3,2] row_mask:0xf bank_mask:0xf
  v_add_f32_dpp v26, v26, v26 quad_perm:[1,0,3,2] row_mask:0xf bank_mask:0xf
  v_add_f32_dpp v27, v27, v27 quad_perm:[1,0,3,2] row_mask:0xf bank_mask:0xf
  v_add_f32_dpp v24, v24, v24 quad_perm:[2,3,0,1] row_mask:0xf bank_mask:0xf
  v_add_f32_dpp v25, v25, v25 quad_perm:[2,3,0,1] row_mask:0xf bank_mask:0xf
  v_add_f32_dpp v26, v26, v26 quad_perm:[2,3,0,1] row_mask:0xf bank_mask:0xf
  v_add_f32_dpp v27, v27, v27 quad_perm:[2,3,0,1] row_mask:0xf bank_mask:0xf
  v_add_f32_dpp v24, v24, v24 row_half_mirror row_mask:0xf bank_mask:0xf
  v_add_f32_dpp v25, v25, v25 row_half_mirror row_mask:0xf bank_mask:0xf
  v_add_f32_dpp v26, v26, v26 row_half_mirror row_mask:0xf bank_mask:0xf
  v_add_f32_dpp v27, v27, v27 row_half_mirror row_mask:0xf bank_mask:0xf
  v_add_f32_dpp v24, v24, v24 row_mirror row_mask:0xf bank_mask:0xf
  v_add_f32_dpp v25, v25, v25 row_mirror row_mask:0xf bank_mask:0xf
  v_add_f32_dpp v26, v26, v26 row_mirror row_mask:0xf bank_mask:0xf
  v_add_f32_dpp v27, v27, v27 row_mirror row_mask:0xf bank_mask:0xf
  v_cvt_pk_bf16_f32 v28, v24, v25
  v_cvt_pk_bf16_f32 v29, v26, v27
  v_lshlrev_b32 v24, 16, v28
  v_and_b32 v25, s46, v28
  v_lshlrev_b32 v26, 16, v29
  v_and_b32 v27, s46, v29
  v_mul_f32 v24, s82, v24
  v_mul_f32 v25, s82, v25
  v_mul_f32 v26, s82, v26
  v_mul_f32 v27, s82, v27
  v_cvt_pk_bf16_f32 v28, v24, v25
  v_cvt_pk_bf16_f32 v29, v26, v27
  v_lshlrev_b32 v24, 16, v28
  v_and_b32 v25, s46, v28
  v_lshlrev_b32 v26, 16, v29
  v_and_b32 v27, s46, v29
  s_mov_b32 s75, s79
  s_mov_b32 s55, s78
  s_add_u32 s67, s67, 1
L_D3_entry:
  s_cmp_eq_u32 s7, 0
  s_cbranch_scc1 L_dinv_D3
  s_cmp_eq_u32 s52, s70
  s_cbranch_scc1 L_nosw_D3
  s_mov_b32 s12, s52
  s_call_b64 s[80:81], L_switch
L_nosw_D3:
  v_max3_f32 v23, v24, v25, v26
  v_max_f32 v23, v23, v27
  v_mul_f32 v23, s47, v23
  v_max_f32 v23, v23, v20
  v_sub_f32 v22, v20, v23
  v_fma_f32 v24, v24, s47, -v23
  v_fma_f32 v25, v25, s47, -v23
  v_fma_f32 v26, v26, s47, -v23
  v_fma_f32 v27, v27, s47, -v23
  v_exp_f32 v22, v22
  v_exp_f32 v24, v24
  v_exp_f32 v25, v25
  v_exp_f32 v26, v26
  v_exp_f32 v27, v27
  v_mov_b32 v20, v23
  v_fma_f32 v21, v21, v22, v24
  v_add_f32 v28, v25, v26
  v_add_f32 v21, v21, v27
  v_add_f32 v21, v21, v28
  v_pk_mul_f32 v[12:13], v[12:13], v[22:23] op_sel_hi:[1,0]
  v_pk_mul_f32 v[14:15], v[14:15], v[22:23] op_sel_hi:[1,0]
  v_pk_mul_f32 v[16:17], v[16:17], v[22:23] op_sel_hi:[1,0]
  v_pk_mul_f32 v[18:19], v[18:19], v[22:23] op_sel_hi:[1,0]
  s_waitcnt vmcnt(12)
  v_lshlrev_b32 v28, 16, v112
  v_and_b32 v29, s46, v112
  v_lshlrev_b32 v30, 16, v113
  v_and_b32 v31, s46, v113
  v_lshlrev_b32 v32, 16, v114
  v_and_b32 v33, s46, v114
  v_lshlrev_b32 v34, 16, v115
  v_and_b32 v35, s46, v115
  v_pk_fma_f32 v[12:13], v[28:29], v[24:25], v[12:13] op_sel_hi:[1,0,1]
  v_pk_fma_f32 v[14:15], v[30:31], v[24:25], v[14:15] op_sel_hi:[1,0,1]
  v_pk_fma_f32 v[16:17], v[32:33], v[24:25], v[16:17] op_sel_hi:[1,0,1]
  v_pk_fma_f32 v[18:19], v[34:35], v[24:25], v[18:19] op_sel_hi:[1,0,1]
  v_lshlrev_b32 v28, 16, v116
  v_and_b32 v29, s46, v116
  v_lshlrev_b32 v30, 16, v117
  v_and_b32 v31, s46, v117
  v_lshlrev_b32 v32, 16, v118
  v_and_b32 v33, s46, v118
  v_lshlrev_b32 v34, 16, v119
  v_and_b32 v35, s46, v119
  v_pk_fma_f32 v[12:13], v[28:29], v[24:25], v[12:13] op_sel:[0,1,0] op_sel_hi:[1,1,1]
  v_pk_fma_f32 v[14:15], v[30:31], v[24:25], v[14:15] op_sel:[0,1,0] op_sel_hi:[1,1,1]
  v_pk_fma_f32 v[16:17], v[32:33], v[24:25], v[16:17] op_sel:[0,1,0] op_sel_hi:[1,1,1]
  v_pk_fma_f32 v[18:19], v[34:35], v[24:25], v[18:19] op_sel:[0,1,0] op_sel_hi:[1,1,1]
  v_lshlrev_b32 v28, 16, v120
  v_and_b32 v29, s46, v120
  v_lshlrev_b32 v30, 16, v121
  v_and_b32 v31, s46, v121
  v_lshlrev_b32 v32, 16, v122
  v_and_b32 v33, s46, v122
  v_lshlrev_b32 v34, 16, v123
  v_and_b32 v35, s46, v123
  v_pk_fma_f32 v[12:13], v[28:29], v[26:27], v[12:13] op_sel_hi:[1,0,1]
  v_pk_fma_f32 v[14:15], v[30:31], v[26:27], v[14:15] op_sel_hi:[1,0,1]
  v_pk_fma_f32 v[16:17], v[32:33], v[26:27], v[16:17] op_sel_hi:[1,0,1]
  v_pk_fma_f32 v[18:19], v[34:35], v[26:27], v[18:19] op_sel_hi:[1,0,1]
  v_lshlrev_b32 v28, 16, v124
  v_and_b32 v29, s46, v124
  v_lshlrev_b32 v30, 16, v125
  v_and_b32 v31, s46, v125
  v_lshlrev_b32 v32, 16, v126
  v_and_b32 v33, s46, v126
  v_lshlrev_b32 v34, 16, v127
  v_and_b32 v35, s46, v127
  v_pk_fma_f32 v[12:13], v[28:29], v[26:27], v[12:13] op_sel:[0,1,0] op_sel_hi:[1,1,1]
  v_pk_fma_f32 v[14:15], v[30:31], v[26:27], v[14:15] op_sel:[0,1,0] op_sel_hi:[1,1,1]
  v_pk_fma_f32 v[16:17], v[32:33], v[26:27], v[16:17] op_sel:[0,1,0] op_sel_hi:[1,1,1]
  v_pk_fma_f32 v[18:19], v[34:35], v[26:27], v[18:19] op_sel:[0,1,0] op_sel_hi:[1,1,1]
  s_mov_b32 s48, s20
  s_mov_b32 s49, s21
  s_mov_b32 s78, s11
  s_mov_b32 s79, s10
  s_cmp_eq_u32 s11, 1
  s_cselect_b32 s69, s9, 0x7ff00000
  buffer_load_dwordx4 v[112:115], v2, s[48:51], s69 offen offset:0 nt
  buffer_load_dwordx4 v[116:119], v2, s[48:51], s69 offen offset:1024 nt
  buffer_load_dwordx4 v[120:123], v2, s[48:51], s69 offen offset:2048 nt
  buffer_load_dwordx4 v[124:127], v2, s[48:51], s69 offen offset:3072 nt
  s_mov_b32 s52, s79
  s_mov_b32 s7, s78
  s_add_u32 s67, s67, 1
  s_branch L_D0_entry
L_dinv_D0:
  s_branch L_sfin
L_dinv_D1:
  s_branch L_sfin
L_dinv_D2:
  s_branch L_sfin
L_dinv_D3:
  s_branch L_sfin
L_kd_K0:
  s_mov_b32 s48, s20
  s_mov_b32 s49, s21
  s_mul_i32 s69, s5, 16384
  s_add_u32 s69, s69, s64
  s_lshl_b32 s76, s5, 6
  v_add_u32 v36, s76, v7
  ds_read_b128 v[40:43], v36
  s_lshr_b32 s79, s44, 1
  s_add_u32 s5, s5, 1
  s_branch L_kld_K0
L_xK0:
  s_add_u32 s72, s72, 1
  s_call_b64 s[80:81], L_xbody
  s_branch L_xK0_ret
L_kd_K1:
  s_mov_b32 s48, s20
  s_mov_b32 s49, s21
  s_mul_i32 s69, s5, 16384
  s_add_u32 s69, s69, s64
  s_lshl_b32 s76, s5, 6
  v_add_u32 v36, s76, v7
  ds_read_b128 v[44:47], v36
  s_lshr_b32 s79, s44, 1
  s_add_u32 s5, s5, 1
  s_branch L_kld_K1
L_xK1:
  s_add_u32 s72, s72, 1
  s_call_b64 s[80:81], L_xbody
  s_branch L_xK1_ret
L_kd_K2:
  s_mov_b32 s48, s20
  s_mov_b32 s49, s21
  s_mul_i32 s69, s5, 16384
  s_add_u32 s69, s69, s64
  s_lshl_b32 s76, s5, 6
  v_add_u32 v36, s76, v7
  ds_read_b128 v[48:51], v36
  s_lshr_b32 s79, s44, 1
  s_add_u32 s5, s5, 1
  s_branch L_kld_K2
L_xK2:
  s_add_u32 s72, s72, 1
  s_call_b64 s[80:81], L_xbody
  s_branch L_xK2_ret
L_kd_K3:
  s_mov_b32 s48, s20
  s_mov_b32 s49, s21
  s_mul_i32 s69, s5, 16384
  s_add_u32 s69, s69, s64
  s_lshl_b32 s76, s5, 6
  v_add_u32 v36, s76, v7
  ds_read_b128 v[52:55], v36
  s_lshr_b32 s79, s44, 1
  s_add_u32 s5, s5, 1
  s_branch L_kld_K3
L_xK3:
  s_add_u32 s72, s72, 1
  s_call_b64 s[80:81], L_xbody
  s_branch L_xK3_ret
L_vd_V0:
  s_mov_b32 s48, s18
  s_mov_b32 s49, s19
  s_mov_b32 s78, 0
  s_mov_b32 s11, 0
  s_cmp_lg_u32 s68, 0
  s_cbranch_scc1 L_nx_V0
  v_readfirstlane_b32 s77, v56
  s_nop 1
  s_cmp_lt_u32 s77, 384
  s_cbranch_scc0 L_ne_V0
  s_mul_i32 s76, s77, 1366
  s_lshr_b32 s76, s76, 16
  s_mul_i32 s69, s76, 48
  s_sub_u32 s69, s77, s69
  s_lshl_b32 s69, s69, 12
  s_add_u32 s69, s69, 851968
  s_add_u32 s69, s69, s65
  s_lshr_b32 s79, s76, 1
  s_and_b32 s76, s76, 1
  s_lshl_b32 s76, s76, 20
  s_add_u32 s69, s69, s76
  s_lshl_b32 s76, s79, 26
  s_add_u32 s69, s69, s76
  s_mov_b32 s9, s69
  s_mov_b32 s10, s79
  s_mov_b32 s11, 1
  s_mov_b32 s78, 1
  v_mov_b32 v56, 1
  s_mov_b64 exec, 1
  buffer_atomic_add v56, v60, s[56:59], 0 offen sc0
  s_mov_b64 exec, -1
  s_branch L_nd_V0
L_ne_V0:
  s_mov_b32 s68, 1
L_nx_V0:
  s_mov_b32 s69, 0x7ff00000
  s_mov_b32 s79, s70
L_nd_V0:
  s_mov_b32 s73, s79
  s_mov_b32 s53, s78
  s_branch L_vld_V0
L_vd_V1:
  s_mov_b32 s48, s20
  s_mov_b32 s49, s21
  s_mov_b32 s78, s11
  s_mov_b32 s79, s10
  s_cmp_eq_u32 s11, 1
  s_cselect_b32 s69, s9, 0x7ff00000
  s_mov_b32 s74, s79
  s_mov_b32 s54, s78
  s_branch L_vld_V1
L_vd_V2:
  s_mov_b32 s48, s18
  s_mov_b32 s49, s19
  s_mov_b32 s78, 0
  s_mov_b32 s11, 0
  s_cmp_lg_u32 s68, 0
  s_cbranch_scc1 L_nx_V2
  v_readfirstlane_b32 s77, v58
  s_nop 1
  s_cmp_lt_u32 s77, 384
  s_cbranch_scc0 L_ne_V2
  s_mul_i32 s76, s77, 1366
  s_lshr_b32 s76, s76, 16
  s_mul_i32 s69, s76, 48
  s_sub_u32 s69, s77, s69
  s_lshl_b32 s69, s69, 12
  s_add_u32 s69, s69, 851968
  s_add_u32 s69, s69, s65
  s_lshr_b32 s79, s76, 1
  s_and_b32 s76, s76, 1
  s_lshl_b32 s76, s76, 20
  s_add_u32 s69, s69, s76
  s_lshl_b32 s76, s79, 26
  s_add_u32 s69, s69, s76
  s_mov_b32 s9, s69
  s_mov_b32 s10, s79
  s_mov_b32 s11, 1
  s_mov_b32 s78, 1
  v_mov_b32 v58, 1
  s_mov_b64 exec, 1
  buffer_atomic_add v58, v60, s[56:59], 0 offen sc0
  s_mov_b64 exec, -1
  s_branch L_nd_V2
L_ne_V2:
  s_mov_b32 s68, 1
L_nx_V2:
  s_mov_b32 s69, 0x7ff00000
  s_mov_b32 s79, s70
L_nd_V2:
  s_mov_b32 s75, s79
  s_mov_b32 s55, s78
  s_branch L_vld_V2
L_vd_V3:
  s_mov_b32 s48, s20
  s_mov_b32 s49, s21
  s_mov_b32 s78, s11
  s_mov_b32 s79, s10
  s_cmp_eq_u32 s11, 1
  s_cselect_b32 s69, s9, 0x7ff00000
  s_mov_b32 s52, s79
  s_mov_b32 s7, s78
  s_branch L_vld_V3
L_xbody:
  s_sub_u32 s3, s72, 1
  s_cmp_le_u32 s72, 8
  s_cbranch_scc1 L_xreg
  s_sub_u32 s77, s72, 9
  s_mul_i32 s76, s42, 16384
  s_lshl_b32 s78, s77, 12
  s_add_u32 s76, s76, s78
  s_add_u32 s76, s76, 88064
  v_add_u32 v36, s76, v2
  ds_read_b128 v[128:131], v36 offset:0
  ds_read_b128 v[132:135], v36 offset:1024
  ds_read_b128 v[136:139], v36 offset:2048
  ds_read_b128 v[140:143], v36 offset:3072
  s_waitcnt lgkmcnt(0)
  s_cmp_eq_u32 s72, 12
  s_cbranch_scc0 L_xb0
  v_mov_b32 v28, 0
  v_mov_b32 v29, 0
  v_mov_b32 v30, 0
  v_mov_b32 v31, 0
  ds_write_b128 v4, v[28:31] offset:0
  ds_write_b128 v4, v[28:31] offset:16
  ds_write_b128 v4, v[28:31] offset:2048
  ds_write_b128 v4, v[28:31] offset:2064
  ds_write_b128 v4, v[28:31] offset:4096
  ds_write_b128 v4, v[28:31] offset:4112
  ds_write_b128 v4, v[28:31] offset:6144
  ds_write_b128 v4, v[28:31] offset:6160
  s_branch L_xb0
L_xreg:
  s_cmp_eq_u32 s72, 1
  s_cbranch_scc0 L_xn0
L_xb0:
  v_dot2_f32_bf16 v24, v128, v8, 0
  v_dot2_f32_bf16 v25, v132, v8, 0
  v_dot2_f32_bf16 v26, v136, v8, 0
  v_dot2_f32_bf16 v27, v140, v8, 0
  v_dot2_f32_bf16 v24, v129, v9, v24
  v_dot2_f32_bf16 v25, v133, v9, v25
  v_dot2_f32_bf16 v26, v137, v9, v26
  v_dot2_f32_bf16 v27, v141, v9, v27
  v_dot2_f32_bf16 v24, v130, v10, v24
  v_dot2_f32_bf16 v25, v134, v10, v25
  v_dot2_f32_bf16 v26, v138, v10, v26
  v_dot2_f32_bf16 v27, v142, v10, v27
  v_dot2_f32_bf16 v24, v131, v11, v24
  v_dot2_f32_bf16 v25, v135, v11, v25
  v_dot2_f32_bf16 v26, v139, v11, v26
  v_dot2_f32_bf16 v27, v143, v11, v27
  s_nop 2
  v_add_f32_dpp v24, v24, v24 quad_perm:[1,0,3,2] row_mask:0xf bank_mask:0xf
  v_add_f32_dpp v25, v25, v25 quad_perm:[1,0,3,2] row_mask:0xf bank_mask:0xf
  v_add_f32_dpp v26, v26, v26 quad_perm:[1,0,3,2] row_mask:0xf bank_mask:0xf
  v_add_f32_dpp v27, v27, v27 quad_perm:[1,0,3,2] row_mask:0xf bank_mask:0xf
  v_add_f32_dpp v24, v24, v24 quad_perm:[2,3,0,1] row_mask:0xf bank_mask:0xf
  v_add_f32_dpp v25, v25, v25 quad_perm:[2,3,0,1] row_mask:0xf bank_mask:0xf
  v_add_f32_dpp v26, v26, v26 quad_perm:[2,3,0,1] row_mask:0xf bank_mask:0xf
  v_add_f32_dpp v27, v27, v27 quad_perm:[2,3,0,1] row_mask:0xf bank_mask:0xf
  v_add_f32_dpp v24, v24, v24 row_half_mirror row_mask:0xf bank_mask:0xf
  v_add_f32_dpp v25, v25, v25 row_half_mirror row_mask:0xf bank_mask:0xf
  v_add_f32_dpp v26, v26, v26 row_half_mirror row_mask:0xf bank_mask:0xf
  v_add_f32_dpp v27, v27, v27 row_half_mirror row_mask:0xf bank_mask:0xf
  v_add_f32_dpp v24, v24, v24 row_mirror row_mask:0xf bank_mask:0xf
  v_add_f32_dpp v25, v25, v25 row_mirror row_mask:0xf bank_mask:0xf
  v_add_f32_dpp v26, v26, v26 row_mirror row_mask:0xf bank_mask:0xf
  v_add_f32_dpp v27, v27, v27 row_mirror row_mask:0xf bank_mask:0xf
  v_cvt_pk_bf16_f32 v28, v24, v25
  v_cvt_pk_bf16_f32 v29, v26, v27
  v_lshlrev_b32 v24, 16, v28
  v_and_b32 v25, s46, v28
  v_lshlrev_b32 v26, 16, v29
  v_and_b32 v27, s46, v29
  v_mul_f32 v24, s82, v24
  v_mul_f32 v25, s82, v25
  v_mul_f32 v26, s82, v26
  v_mul_f32 v27, s82, v27
  v_cvt_pk_bf16_f32 v28, v24, v25
  v_cvt_pk_bf16_f32 v29, v26, v27
  v_lshlrev_b32 v24, 16, v28
  v_and_b32 v25, s46, v28
  v_lshlrev_b32 v26, 16, v29
  v_and_b32 v27, s46, v29
  s_lshl_b32 s76, s3, 6
  v_add_u32 v36, s76, v7
  s_mov_b32 exec_lo, 0x00010001
  s_mov_b32 exec_hi, 0x00010001
  ds_write_b128 v36, v[24:27]
  s_mov_b64 exec, -1
  s_setpc_b64 s[80:81]
L_xn0:
  s_cmp_eq_u32 s72, 2
  s_cbranch_scc0 L_xn1
L_xb1:
  v_dot2_f32_bf16 v24, v144, v8, 0
  v_dot2_f32_bf16 v25, v148, v8, 0
  v_dot2_f32_bf16 v26, v152, v8, 0
  v_dot2_f32_bf16 v27, v156, v8, 0
  v_dot2_f32_bf16 v24, v145, v9, v24
  v_dot2_f32_bf16 v25, v149, v9, v25
  v_dot2_f32_bf16 v26, v153, v9, v26
  v_dot2_f32_bf16 v27, v157, v9, v27
  v_dot2_f32_bf16 v24, v146, v10, v24
  v_dot2_f32_bf16 v25, v150, v10, v25
  v_dot2_f32_bf16 v26, v154, v10, v26
  v_dot2_f32_bf16 v27, v158, v10, v27
  v_dot2_f32_bf16 v24, v147, v11, v24
  v_dot2_f32_bf16 v25, v151, v11, v25
  v_dot2_f32_bf16 v26, v155, v11, v26
  v_dot2_f32_bf16 v27, v159, v11, v27
  s_nop 2
  v_add_f32_dpp v24, v24, v24 quad_perm:[1,0,3,2] row_mask:0xf bank_mask:0xf
  v_add_f32_dpp v25, v25, v25 quad_perm:[1,0,3,2] row_mask:0xf bank_mask:0xf
  v_add_f32_dpp v26, v26, v26 quad_perm:[1,0,3,2] row_mask:0xf bank_mask:0xf
  v_add_f32_dpp v27, v27, v27 quad_perm:[1,0,3,2] row_mask:0xf bank_mask:0xf
  v_add_f32_dpp v24, v24, v24 quad_perm:[2,3,0,1] row_mask:0xf bank_mask:0xf
  v_add_f32_dpp v25, v25, v25 quad_perm:[2,3,0,1] row_mask:0xf bank_mask:0xf
  v_add_f32_dpp v26, v26, v26 quad_perm:[2,3,0,1] row_mask:0xf bank_mask:0xf
  v_add_f32_dpp v27, v27, v27 quad_perm:[2,3,0,1] row_mask:0xf bank_mask:0xf
  v_add_f32_dpp v24, v24, v24 row_half_mirror row_mask:0xf bank_mask:0xf
  v_add_f32_dpp v25, v25, v25 row_half_mirror row_mask:0xf bank_mask:0xf
  v_add_f32_dpp v26, v26, v26 row_half_mirror row_mask:0xf bank_mask:0xf
  v_add_f32_dpp v27, v27, v27 row_half_mirror row_mask:0xf bank_mask:0xf
  v_add_f32_dpp v24, v24, v24 row_mirror row_mask:0xf bank_mask:0xf
  v_add_f32_dpp v25, v25, v25 row_mirror row_mask:0xf bank_mask:0xf
  v_add_f32_dpp v26, v26, v26 row_mirror row_mask:0xf bank_mask:0xf
  v_add_f32_dpp v27, v27, v27 row_mirror row_mask:0xf bank_mask:0xf
  v_cvt_pk_bf16_f32 v28, v24, v25
  v_cvt_pk_bf16_f32 v29, v26, v27
  v_lshlrev_b32 v24, 16, v28
  v_and_b32 v25, s46, v28
  v_lshlrev_b32 v26, 16, v29
  v_and_b32 v27, s46, v29
  v_mul_f32 v24, s82, v24
  v_mul_f32 v25, s82, v25
  v_mul_f32 v26, s82, v26
  v_mul_f32 v27, s82, v27
  v_cvt_pk_bf16_f32 v28, v24, v25
  v_cvt_pk_bf16_f32 v29, v26, v27
  v_lshlrev_b32 v24, 16, v28
  v_and_b32 v25, s46, v28
  v_lshlrev_b32 v26, 16, v29
  v_and_b32 v27, s46, v29
  s_lshl_b32 s76, s3, 6
  v_add_u32 v36, s76, v7
  s_mov_b32 exec_lo, 0x00010001
  s_mov_b32 exec_hi, 0x00010001
  ds_write_b128 v36, v[24:27]
  s_mov_b64 exec, -1
  s_setpc_b64 s[80:81]
L_xn1:
  s_cmp_eq_u32 s72, 3
  s_cbranch_scc0 L_xn2
L_xb2:
  v_dot2_f32_bf16 v24, v160, v8, 0
  v_dot2_f32_bf16 v25, v164, v8, 0
  v_dot2_f32_bf16 v26, v168, v8, 0
  v_dot2_f32_bf16 v27, v172, v8, 0
  v_dot2_f32_bf16 v24, v161, v9, v24
  v_dot2_f32_bf16 v25, v165, v9, v25
  v_dot2_f32_bf16 v26, v169, v9, v26
  v_dot2_f32_bf16 v27, v173, v9, v27
  v_dot2_f32_bf16 v24, v162, v10, v24
  v_dot2_f32_bf16 v25, v166, v10, v25
  v_dot2_f32_bf16 v26, v170, v10, v26
  v_dot2_f32_bf16 v27, v174, v10, v27
  v_dot2_f32_bf16 v24, v163, v11, v24
  v_dot2_f32_bf16 v25, v167, v11, v25
  v_dot2_f32_bf16 v26, v171, v11, v26
  v_dot2_f32_bf16 v27, v175, v11, v27
  s_nop 2
  v_add_f32_dpp v24, v24, v24 quad_perm:[1,0,3,2] row_mask:0xf bank_mask:0xf
  v_add_f32_dpp v25, v25, v25 quad_perm:[1,0,3,2] row_mask:0xf bank_mask:0xf
  v_add_f32_dpp v26, v26, v26 quad_perm:[1,0,3,2] row_mask:0xf bank_mask:0xf
  v_add_f32_dpp v27, v27, v27 quad_perm:[1,0,3,2] row_mask:0xf bank_mask:0xf
  v_add_f32_dpp v24, v24, v24 quad_perm:[2,3,0,1] row_mask:0xf bank_mask:0xf
  v_add_f32_dpp v25, v25, v25 quad_perm:[2,3,0,1] row_mask:0xf bank_mask:0xf
  v_add_f32_dpp v26, v26, v26 quad_perm:[2,3,0,1] row_mask:0xf bank_mask:0xf
  v_add_f32_dpp v27, v27, v27 quad_perm:[2,3,0,1] row_mask:0xf bank_mask:0xf
  v_add_f32_dpp v24, v24, v24 row_half_mirror row_mask:0xf bank_mask:0xf
  v_add_f32_dpp v25, v25, v25 row_half_mirror row_mask:0xf bank_mask:0xf
  v_add_f32_dpp v26, v26, v26 row_half_mirror row_mask:0xf bank_mask:0xf
  v_add_f32_dpp v27, v27, v27 row_half_mirror row_mask:0xf bank_mask:0xf
  v_add_f32_dpp v24, v24, v24 row_mirror row_mask:0xf bank_mask:0xf
  v_add_f32_dpp v25, v25, v25 row_mirror row_mask:0xf bank_mask:0xf
  v_add_f32_dpp v26, v26, v26 row_mirror row_mask:0xf bank_mask:0xf
  v_add_f32_dpp v27, v27, v27 row_mirror row_mask:0xf bank_mask:0xf
  v_cvt_pk_bf16_f32 v28, v24, v25
  v_cvt_pk_bf16_f32 v29, v26, v27
  v_lshlrev_b32 v24, 16, v28
  v_and_b32 v25, s46, v28
  v_lshlrev_b32 v26, 16, v29
  v_and_b32 v27, s46, v29
  v_mul_f32 v24, s82, v24
  v_mul_f32 v25, s82, v25
  v_mul_f32 v26, s82, v26
  v_mul_f32 v27, s82, v27
  v_cvt_pk_bf16_f32 v28, v24, v25
  v_cvt_pk_bf16_f32 v29, v26, v27
  v_lshlrev_b32 v24, 16, v28
  v_and_b32 v25, s46, v28
  v_lshlrev_b32 v26, 16, v29
  v_and_b32 v27, s46, v29
  s_lshl_b32 s76, s3, 6
  v_add_u32 v36, s76, v7
  s_mov_b32 exec_lo, 0x00010001
  s_mov_b32 exec_hi, 0x00010001
  ds_write_b128 v36, v[24:27]
  s_mov_b64 exec, -1
  s_setpc_b64 s[80:81]
L_xn2:
  s_cmp_eq_u32 s72, 4
  s_cbranch_scc0 L_xn3
L_xb3:
  v_dot2_f32_bf16 v24, v176, v8, 0
  v_dot2_f32_bf16 v25, v180, v8, 0
  v_dot2_f32_bf16 v26, v184, v8, 0
  v_dot2_f32_bf16 v27, v188, v8, 0
  v_dot2_f32_bf16 v24, v177, v9, v24
  v_dot2_f32_bf16 v25, v181, v9, v25
  v_dot2_f32_bf16 v26, v185, v9, v26
  v_dot2_f32_bf16 v27, v189, v9, v27
  v_dot2_f32_bf16 v24, v178, v10, v24
  v_dot2_f32_bf16 v25, v182, v10, v25
  v_dot2_f32_bf16 v26, v186, v10, v26
  v_dot2_f32_bf16 v27, v190, v10, v27
  v_dot2_f32_bf16 v24, v179, v11, v24
  v_dot2_f32_bf16 v25, v183, v11, v25
  v_dot2_f32_bf16 v26, v187, v11, v26
  v_dot2_f32_bf16 v27, v191, v11, v27
  s_nop 2
  v_add_f32_dpp v24, v24, v24 quad_perm:[1,0,3,2] row_mask:0xf bank_mask:0xf
  v_add_f32_dpp v25, v25, v25 quad_perm:[1,0,3,2] row_mask:0xf bank_mask:0xf
  v_add_f32_dpp v26, v26, v26 quad_perm:[1,0,3,2] row_mask:0xf bank_mask:0xf
  v_add_f32_dpp v27, v27, v27 quad_perm:[1,0,3,2] row_mask:0xf bank_mask:0xf
  v_add_f32_dpp v24, v24, v24 quad_perm:[2,3,0,1] row_mask:0xf bank_mask:0xf
  v_add_f32_dpp v25, v25, v25 quad_perm:[2,3,0,1] row_mask:0xf bank_mask:0xf
  v_add_f32_dpp v26, v26, v26 quad_perm:[2,3,0,1] row_mask:0xf bank_mask:0xf
  v_add_f32_dpp v27, v27, v27 quad_perm:[2,3,0,1] row_mask:0xf bank_mask:0xf
  v_add_f32_dpp v24, v24, v24 row_half_mirror row_mask:0xf bank_mask:0xf
  v_add_f32_dpp v25, v25, v25 row_half_mirror row_mask:0xf bank_mask:0xf
  v_add_f32_dpp v26, v26, v26 row_half_mirror row_mask:0xf bank_mask:0xf
  v_add_f32_dpp v27, v27, v27 row_half_mirror row_mask:0xf bank_mask:0xf
  v_add_f32_dpp v24, v24, v24 row_mirror row_mask:0xf bank_mask:0xf
  v_add_f32_dpp v25, v25, v25 row_mirror row_mask:0xf bank_mask:0xf
  v_add_f32_dpp v26, v26, v26 row_mirror row_mask:0xf bank_mask:0xf
  v_add_f32_dpp v27, v27, v27 row_mirror row_mask:0xf bank_mask:0xf
  v_cvt_pk_bf16_f32 v28, v24, v25
  v_cvt_pk_bf16_f32 v29, v26, v27
  v_lshlrev_b32 v24, 16, v28
  v_and_b32 v25, s46, v28
  v_lshlrev_b32 v26, 16, v29
  v_and_b32 v27, s46, v29
  v_mul_f32 v24, s82, v24
  v_mul_f32 v25, s82, v25
  v_mul_f32 v26, s82, v26
  v_mul_f32 v27, s82, v27
  v_cvt_pk_bf16_f32 v28, v24, v25
  v_cvt_pk_bf16_f32 v29, v26, v27
  v_lshlrev_b32 v24, 16, v28
  v_and_b32 v25, s46, v28
  v_lshlrev_b32 v26, 16, v29
  v_and_b32 v27, s46, v29
  s_lshl_b32 s76, s3, 6
  v_add_u32 v36, s76, v7
  s_mov_b32 exec_lo, 0x00010001
  s_mov_b32 exec_hi, 0x00010001
  ds_write_b128 v36, v[24:27]
  s_mov_b64 exec, -1
  s_setpc_b64 s[80:81]
L_xn3:
  s_cmp_eq_u32 s72, 5
  s_cbranch_scc0 L_xn4
L_xb4:
  v_dot2_f32_bf16 v24, v192, v8, 0
  v_dot2_f32_bf16 v25, v196, v8, 0
  v_dot2_f32_bf16 v26, v200, v8, 0
  v_dot2_f32_bf16 v27, v204, v8, 0
  v_dot2_f32_bf16 v24, v193, v9, v24
  v_dot2_f32_bf16 v25, v197, v9, v25
  v_dot2_f32_bf16 v26, v201, v9, v26
  v_dot2_f32_bf16 v27, v205, v9, v27
  v_dot2_f32_bf16 v24, v194, v10, v24
  v_dot2_f32_bf16 v25, v198, v10, v25
  v_dot2_f32_bf16 v26, v202, v10, v26
  v_dot2_f32_bf16 v27, v206, v10, v27
  v_dot2_f32_bf16 v24, v195, v11, v24
  v_dot2_f32_bf16 v25, v199, v11, v25
  v_dot2_f32_bf16 v26, v203, v11, v26
  v_dot2_f32_bf16 v27, v207, v11, v27
  s_nop 2
  v_add_f32_dpp v24, v24, v24 quad_perm:[1,0,3,2] row_mask:0xf bank_mask:0xf
  v_add_f32_dpp v25, v25, v25 quad_perm:[1,0,3,2] row_mask:0xf bank_mask:0xf
  v_add_f32_dpp v26, v26, v26 quad_perm:[1,0,3,2] row_mask:0xf bank_mask:0xf
  v_add_f32_dpp v27, v27, v27 quad_perm:[1,0,3,2] row_mask:0xf bank_mask:0xf
  v_add_f32_dpp v24, v24, v24 quad_perm:[2,3,0,1] row_mask:0xf bank_mask:0xf
  v_add_f32_dpp v25, v25, v25 quad_perm:[2,3,0,1] row_mask:0xf bank_mask:0xf
  v_add_f32_dpp v26, v26, v26 quad_perm:[2,3,0,1] row_mask:0xf bank_mask:0xf
  v_add_f32_dpp v27, v27, v27 quad_perm:[2,3,0,1] row_mask:0xf bank_mask:0xf
  v_add_f32_dpp v24, v24, v24 row_half_mirror row_mask:0xf bank_mask:0xf
  v_add_f32_dpp v25, v25, v25 row_half_mirror row_mask:0xf bank_mask:0xf
  v_add_f32_dpp v26, v26, v26 row_half_mirror row_mask:0xf bank_mask:0xf
  v_add_f32_dpp v27, v27, v27 row_half_mirror row_mask:0xf bank_mask:0xf
  v_add_f32_dpp v24, v24, v24 row_mirror row_mask:0xf bank_mask:0xf
  v_add_f32_dpp v25, v25, v25 row_mirror row_mask:0xf bank_mask:0xf
  v_add_f32_dpp v26, v26, v26 row_mirror row_mask:0xf bank_mask:0xf
  v_add_f32_dpp v27, v27, v27 row_mirror row_mask:0xf bank_mask:0xf
  v_cvt_pk_bf16_f32 v28, v24, v25
  v_cvt_pk_bf16_f32 v29, v26, v27
  v_lshlrev_b32 v24, 16, v28
  v_and_b32 v25, s46, v28
  v_lshlrev_b32 v26, 16, v29
  v_and_b32 v27, s46, v29
  v_mul_f32 v24, s82, v24
  v_mul_f32 v25, s82, v25
  v_mul_f32 v26, s82, v26
  v_mul_f32 v27, s82, v27
  v_cvt_pk_bf16_f32 v28, v24, v25
  v_cvt_pk_bf16_f32 v29, v26, v27
  v_lshlrev_b32 v24, 16, v28
  v_and_b32 v25, s46, v28
  v_lshlrev_b32 v26, 16, v29
  v_and_b32 v27, s46, v29
  s_lshl_b32 s76, s3, 6
  v_add_u32 v36, s76, v7
  s_mov_b32 exec_lo, 0x00010001
  s_mov_b32 exec_hi, 0x00010001
  ds_write_b128 v36, v[24:27]
  s_mov_b64 exec, -1
  s_setpc_b64 s[80:81]
L_xn4:
  s_cmp_eq_u32 s72, 6
  s_cbranch_scc0 L_xn5
L_xb5:
  v_dot2_f32_bf16 v24, v208, v8, 0
  v_dot2_f32_bf16 v25, v212, v8, 0
  v_dot2_f32_bf16 v26, v216, v8, 0
  v_dot2_f32_bf16 v27, v220, v8, 0
  v_dot2_f32_bf16 v24, v209, v9, v24
  v_dot2_f32_bf16 v25, v213, v9, v25
  v_dot2_f32_bf16 v26, v217, v9, v26
  v_dot2_f32_bf16 v27, v221, v9, v27
  v_dot2_f32_bf16 v24, v210, v10, v24
  v_dot2_f32_bf16 v25, v214, v10, v25
  v_dot2_f32_bf16 v26, v218, v10, v26
  v_dot2_f32_bf16 v27, v222, v10, v27
  v_dot2_f32_bf16 v24, v211, v11, v24
  v_dot2_f32_bf16 v25, v215, v11, v25
  v_dot2_f32_bf16 v26, v219, v11, v26
  v_dot2_f32_bf16 v27, v223, v11, v27
  s_nop 2
  v_add_f32_dpp v24, v24, v24 quad_perm:[1,0,3,2] row_mask:0xf bank_mask:0xf
  v_add_f32_dpp v25, v25, v25 quad_perm:[1,0,3,2] row_mask:0xf bank_mask:0xf
  v_add_f32_dpp v26, v26, v26 quad_perm:[1,0,3,2] row_mask:0xf bank_mask:0xf
  v_add_f32_dpp v27, v27, v27 quad_perm:[1,0,3,2] row_mask:0xf bank_mask:0xf
  v_add_f32_dpp v24, v24, v24 quad_perm:[2,3,0,1] row_mask:0xf bank_mask:0xf
  v_add_f32_dpp v25, v25, v25 quad_perm:[2,3,0,1] row_mask:0xf bank_mask:0xf
  v_add_f32_dpp v26, v26, v26 quad_perm:[2,3,0,1] row_mask:0xf bank_mask:0xf
  v_add_f32_dpp v27, v27, v27 quad_perm:[2,3,0,1] row_mask:0xf bank_mask:0xf
  v_add_f32_dpp v24, v24, v24 row_half_mirror row_mask:0xf bank_mask:0xf
  v_add_f32_dpp v25, v25, v25 row_half_mirror row_mask:0xf bank_mask:0xf
  v_add_f32_dpp v26, v26, v26 row_half_mirror row_mask:0xf bank_mask:0xf
  v_add_f32_dpp v27, v27, v27 row_half_mirror row_mask:0xf bank_mask:0xf
  v_add_f32_dpp v24, v24, v24 row_mirror row_mask:0xf bank_mask:0xf
  v_add_f32_dpp v25, v25, v25 row_mirror row_mask:0xf bank_mask:0xf
  v_add_f32_dpp v26, v26, v26 row_mirror row_mask:0xf bank_mask:0xf
  v_add_f32_dpp v27, v27, v27 row_mirror row_mask:0xf bank_mask:0xf
  v_cvt_pk_bf16_f32 v28, v24, v25
  v_cvt_pk_bf16_f32 v29, v26, v27
  v_lshlrev_b32 v24, 16, v28
  v_and_b32 v25, s46, v28
  v_lshlrev_b32 v26, 16, v29
  v_and_b32 v27, s46, v29
  v_mul_f32 v24, s82, v24
  v_mul_f32 v25, s82, v25
  v_mul_f32 v26, s82, v26
  v_mul_f32 v27, s82, v27
  v_cvt_pk_bf16_f32 v28, v24, v25
  v_cvt_pk_bf16_f32 v29, v26, v27
  v_lshlrev_b32 v24, 16, v28
  v_and_b32 v25, s46, v28
  v_lshlrev_b32 v26, 16, v29
  v_and_b32 v27, s46, v29
  s_lshl_b32 s76, s3, 6
  v_add_u32 v36, s76, v7
  s_mov_b32 exec_lo, 0x00010001
  s_mov_b32 exec_hi, 0x00010001
  ds_write_b128 v36, v[24:27]
  s_mov_b64 exec, -1
  s_setpc_b64 s[80:81]
L_xn5:
  s_cmp_eq_u32 s72, 7
  s_cbranch_scc0 L_xn6
L_xb6:
  v_dot2_f32_bf16 v24, v224, v8, 0
  v_dot2_f32_bf16 v25, v228, v8, 0
  v_dot2_f32_bf16 v26, v232, v8, 0
  v_dot2_f32_bf16 v27, v236, v8, 0
  v_dot2_f32_bf16 v24, v225, v9, v24
  v_dot2_f32_bf16 v25, v229, v9, v25
  v_dot2_f32_bf16 v26, v233, v9, v26
  v_dot2_f32_bf16 v27, v237, v9, v27
  v_dot2_f32_bf16 v24, v226, v10, v24
  v_dot2_f32_bf16 v25, v230, v10, v25
  v_dot2_f32_bf16 v26, v234, v10, v26
  v_dot2_f32_bf16 v27, v238, v10, v27
  v_dot2_f32_bf16 v24, v227, v11, v24
  v_dot2_f32_bf16 v25, v231, v11, v25
  v_dot2_f32_bf16 v26, v235, v11, v26
  v_dot2_f32_bf16 v27, v239, v11, v27
  s_nop 2
  v_add_f32_dpp v24, v24, v24 quad_perm:[1,0,3,2] row_mask:0xf bank_mask:0xf
  v_add_f32_dpp v25, v25, v25 quad_perm:[1,0,3,2] row_mask:0xf bank_mask:0xf
  v_add_f32_dpp v26, v26, v26 quad_perm:[1,0,3,2] row_mask:0xf bank_mask:0xf
  v_add_f32_dpp v27, v27, v27 quad_perm:[1,0,3,2] row_mask:0xf bank_mask:0xf
  v_add_f32_dpp v24, v24, v24 quad_perm:[2,3,0,1] row_mask:0xf bank_mask:0xf
  v_add_f32_dpp v25, v25, v25 quad_perm:[2,3,0,1] row_mask:0xf bank_mask:0xf
  v_add_f32_dpp v26, v26, v26 quad_perm:[2,3,0,1] row_mask:0xf bank_mask:0xf
  v_add_f32_dpp v27, v27, v27 quad_perm:[2,3,0,1] row_mask:0xf bank_mask:0xf
  v_add_f32_dpp v24, v24, v24 row_half_mirror row_mask:0xf bank_mask:0xf
  v_add_f32_dpp v25, v25, v25 row_half_mirror row_mask:0xf bank_mask:0xf
  v_add_f32_dpp v26, v26, v26 row_half_mirror row_mask:0xf bank_mask:0xf
  v_add_f32_dpp v27, v27, v27 row_half_mirror row_mask:0xf bank_mask:0xf
  v_add_f32_dpp v24, v24, v24 row_mirror row_mask:0xf bank_mask:0xf
  v_add_f32_dpp v25, v25, v25 row_mirror row_mask:0xf bank_mask:0xf
  v_add_f32_dpp v26, v26, v26 row_mirror row_mask:0xf bank_mask:0xf
  v_add_f32_dpp v27, v27, v27 row_mirror row_mask:0xf bank_mask:0xf
  v_cvt_pk_bf16_f32 v28, v24, v25
  v_cvt_pk_bf16_f32 v29, v26, v27
  v_lshlrev_b32 v24, 16, v28
  v_and_b32 v25, s46, v28
  v_lshlrev_b32 v26, 16, v29
  v_and_b32 v27, s46, v29
  v_mul_f32 v24, s82, v24
  v_mul_f32 v25, s82, v25
  v_mul_f32 v26, s82, v26
  v_mul_f32 v27, s82, v27
  v_cvt_pk_bf16_f32 v28, v24, v25
  v_cvt_pk_bf16_f32 v29, v26, v27
  v_lshlrev_b32 v24, 16, v28
  v_and_b32 v25, s46, v28
  v_lshlrev_b32 v26, 16, v29
  v_and_b32 v27, s46, v29
  s_lshl_b32 s76, s3, 6
  v_add_u32 v36, s76, v7
  s_mov_b32 exec_lo, 0x00010001
  s_mov_b32 exec_hi, 0x00010001
  ds_write_b128 v36, v[24:27]
  s_mov_b64 exec, -1
  s_setpc_b64 s[80:81]
L_xn6:
L_xb7:
  v_dot2_f32_bf16 v24, v240, v8, 0
  v_dot2_f32_bf16 v25, v244, v8, 0
  v_dot2_f32_bf16 v26, v248, v8, 0
  v_dot2_f32_bf16 v27, v252, v8, 0
  v_dot2_f32_bf16 v24, v241, v9, v24
  v_dot2_f32_bf16 v25, v245, v9, v25
  v_dot2_f32_bf16 v26, v249, v9, v26
  v_dot2_f32_bf16 v27, v253, v9, v27
  v_dot2_f32_bf16 v24, v242, v10, v24
  v_dot2_f32_bf16 v25, v246, v10, v25
  v_dot2_f32_bf16 v26, v250, v10, v26
  v_dot2_f32_bf16 v27, v254, v10, v27
  v_dot2_f32_bf16 v24, v243, v11, v24
  v_dot2_f32_bf16 v25, v247, v11, v25
  v_dot2_f32_bf16 v26, v251, v11, v26
  v_dot2_f32_bf16 v27, v255, v11, v27
  s_nop 2
  v_add_f32_dpp v24, v24, v24 quad_perm:[1,0,3,2] row_mask:0xf bank_mask:0xf
  v_add_f32_dpp v25, v25, v25 quad_perm:[1,0,3,2] row_mask:0xf bank_mask:0xf
  v_add_f32_dpp v26, v26, v26 quad_perm:[1,0,3,2] row_mask:0xf bank_mask:0xf
  v_add_f32_dpp v27, v27, v27 quad_perm:[1,0,3,2] row_mask:0xf bank_mask:0xf
  v_add_f32_dpp v24, v24, v24 quad_perm:[2,3,0,1] row_mask:0xf bank_mask:0xf
  v_add_f32_dpp v25, v25, v25 quad_perm:[2,3,0,1] row_mask:0xf bank_mask:0xf
  v_add_f32_dpp v26, v26, v26 quad_perm:[2,3,0,1] row_mask:0xf bank_mask:0xf
  v_add_f32_dpp v27, v27, v27 quad_perm:[2,3,0,1] row_mask:0xf bank_mask:0xf
  v_add_f32_dpp v24, v24, v24 row_half_mirror row_mask:0xf bank_mask:0xf
  v_add_f32_dpp v25, v25, v25 row_half_mirror row_mask:0xf bank_mask:0xf
  v_add_f32_dpp v26, v26, v26 row_half_mirror row_mask:0xf bank_mask:0xf
  v_add_f32_dpp v27, v27, v27 row_half_mirror row_mask:0xf bank_mask:0xf
  v_add_f32_dpp v24, v24, v24 row_mirror row_mask:0xf bank_mask:0xf
  v_add_f32_dpp v25, v25, v25 row_mirror row_mask:0xf bank_mask:0xf
  v_add_f32_dpp v26, v26, v26 row_mirror row_mask:0xf bank_mask:0xf
  v_add_f32_dpp v27, v27, v27 row_mirror row_mask:0xf bank_mask:0xf
  v_cvt_pk_bf16_f32 v28, v24, v25
  v_cvt_pk_bf16_f32 v29, v26, v27
  v_lshlrev_b32 v24, 16, v28
  v_and_b32 v25, s46, v28
  v_lshlrev_b32 v26, 16, v29
  v_and_b32 v27, s46, v29
  v_mul_f32 v24, s82, v24
  v_mul_f32 v25, s82, v25
  v_mul_f32 v26, s82, v26
  v_mul_f32 v27, s82, v27
  v_cvt_pk_bf16_f32 v28, v24, v25
  v_cvt_pk_bf16_f32 v29, v26, v27
  v_lshlrev_b32 v24, 16, v28
  v_and_b32 v25, s46, v28
  v_lshlrev_b32 v26, 16, v29
  v_and_b32 v27, s46, v29
  s_lshl_b32 s76, s3, 6
  v_add_u32 v36, s76, v7
  s_mov_b32 exec_lo, 0x00010001
  s_mov_b32 exec_hi, 0x00010001
  ds_write_b128 v36, v[24:27]
  s_mov_b64 exec, -1
  s_setpc_b64 s[80:81]
L_switch:
  s_lshl_b32 s76, s70, 11
  v_add_u32 v36, s76, v4
  ds_write_b128 v36, v[12:15]
  ds_write_b128 v36, v[16:19] offset:16
  s_lshl_b32 s76, s70, 7
  v_add_u32 v37, s76, v5
  ds_write_b64 v37, v[20:21]
  s_mov_b32 s70, s12
  s_lshl_b32 s76, s70, 11
  v_add_u32 v36, s76, v4
  ds_read_b128 v[12:15], v36
  ds_read_b128 v[16:19], v36 offset:16
  s_lshl_b32 s76, s70, 7
  v_add_u32 v37, s76, v5
  ds_read_b64 v[20:21], v37
  s_waitcnt lgkmcnt(0)
  s_setpc_b64 s[80:81]
L_sfin:
  s_lshl_b32 s76, s70, 11
  v_add_u32 v36, s76, v4
  ds_write_b128 v36, v[12:15]
  ds_write_b128 v36, v[16:19] offset:16
  s_lshl_b32 s76, s70, 7
  v_add_u32 v37, s76, v5
  ds_write_b64 v37, v[20:21]
  s_waitcnt lgkmcnt(0)
  s_barrier
  s_cmp_lt_u32 s43, 4
  s_cbranch_scc0 L_fin_stamp
  s_cmp_lt_u32 s44, 5
  s_cbranch_scc0 L_fin_stamp
  s_branch L_final_pre
L_h_post:
  v_lshlrev_b32 v205, 1, v1
  s_cmp_lt_u32 s44, 5
  s_cbranch_scc0 L_h_notile
  v_lshrrev_b32 v8, 4, v1
  v_mul_u32_u24 v8, 1280, v8
  v_and_b32 v9, 15, v1
  v_lshlrev_b32 v9, 4, v9
  v_add_u32 v8, v8, v9
  s_mov_b32 s56, s24
  s_mov_b32 s57, s25
  s_mov_b32 s58, 5242880
  s_mov_b32 s59, 0x20000
  s_mov_b32 s60, s32
  s_mov_b32 s61, s33
  s_mov_b32 s62, 2211840
  s_mov_b32 s63, 0x20000
  s_lshl_b32 s76, s43, 7
  s_lshl_b32 s77, s45, 5
  s_add_u32 s76, s76, s77
  s_mul_i32 s76, s76, 1280
  s_lshl_b32 s77, s44, 8
  s_add_u32 s76, s76, s77
  s_lshl_b32 s78, s45, 13
  s_add_u32 s78, s78, 22528
  s_add_u32 m0, s78, 0
  s_nop 0
  buffer_load_dwordx4 v8, s[56:59], s76 offen nt lds
  s_add_u32 s76, s76, 5120
  s_add_u32 m0, s78, 1024
  s_nop 0
  buffer_load_dwordx4 v8, s[56:59], s76 offen nt lds
  s_add_u32 s76, s76, 5120
  s_add_u32 m0, s78, 2048
  s_nop 0
  buffer_load_dwordx4 v8, s[56:59], s76 offen nt lds
  s_add_u32 s76, s76, 5120
  s_add_u32 m0, s78, 3072
  s_nop 0
  buffer_load_dwordx4 v8, s[56:59], s76 offen nt lds
  s_add_u32 s76, s76, 5120
  s_add_u32 m0, s78, 4096
  s_nop 0
  buffer_load_dwordx4 v8, s[56:59], s76 offen nt lds
  s_add_u32 s76, s76, 5120
  s_add_u32 m0, s78, 5120
  s_nop 0
  buffer_load_dwordx4 v8, s[56:59], s76 offen nt lds
  s_add_u32 s76, s76, 5120
  s_add_u32 m0, s78, 6144
  s_nop 0
  buffer_load_dwordx4 v8, s[56:59], s76 offen nt lds
  s_add_u32 s76, s76, 5120
  s_add_u32 m0, s78, 7168
  s_nop 0
  buffer_load_dwordx4 v8, s[56:59], s76 offen nt lds
  s_add_u32 s76, s76, 5120
  s_lshl_b32 s76, s43, 6
  s_lshl_b32 s79, s45, 4
  s_add_u32 s76, s76, s79
  s_mul_i32 s76, s76, 1280
  s_add_u32 s76, s76, s77
  s_lshl_b32 s78, s45, 12
  s_add_u32 s78, s78, 55296
  s_add_u32 m0, s78, 0
  s_nop 0
  buffer_load_dwordx4 v8, s[60:63], s76 offen nt lds
  s_add_u32 s76, s76, 5120
  s_add_u32 m0, s78, 1024
  s_nop 0
  buffer_load_dwordx4 v8, s[60:63], s76 offen nt lds
  s_add_u32 s76, s76, 5120
  s_add_u32 m0, s78, 2048
  s_nop 0
  buffer_load_dwordx4 v8, s[60:63], s76 offen nt lds
  s_add_u32 s76, s76, 5120
  s_add_u32 m0, s78, 3072
  s_nop 0
  buffer_load_dwordx4 v8, s[60:63], s76 offen nt lds
  s_add_u32 s76, s76, 5120
  s_waitcnt vmcnt(0)
  s_mov_b64 exec, 1
  ds_add_u32 v6, v7 offset:24
  s_mov_b64 exec, -1
  v_lshrrev_b32 v152, 4, v1
  v_lshlrev_b32 v204, 11, v152
  v_and_b32 v153, 15, v1
  v_lshlrev_b32 v153, 1, v153
  v_add_u32 v204, v204, v153
  s_lshl_b32 s77, s45, 6
  v_add_u32 v204, s77, v204
L_lw_18:
  ds_read_b32 v156, v6 offset:24
  s_waitcnt lgkmcnt(0)
  v_readfirstlane_b32 s76, v156
  s_nop 1
  s_cmp_ge_u32 s76, 4
  s_cbranch_scc1 L_lwok_19
  s_sleep 1
  s_cmp_eq_u32 s83, 0
  s_cbranch_scc1 L_to_20
  s_sub_u32 s83, s83, 1
  s_branch L_lw_18
L_to_20:
L_lwok_19:
  ds_read_u16 v64, v204 offset:22528
  ds_read_u16 v65, v204 offset:22784
  ds_read_u16 v66, v204 offset:23040
  ds_read_u16 v67, v204 offset:23296
  ds_read_u16 v68, v204 offset:23552
  ds_read_u16 v69, v204 offset:23808
  ds_read_u16 v70, v204 offset:24064
  ds_read_u16 v71, v204 offset:24320
  s_waitcnt lgkmcnt(0)
  v_lshl_or_b32 v172, v65, 16, v64
  v_lshl_or_b32 v173, v67, 16, v66
  v_lshl_or_b32 v174, v69, 16, v68
  v_lshl_or_b32 v175, v71, 16, v70
  ds_read_u16 v72, v204 offset:30720
  ds_read_u16 v73, v204 offset:30976
  ds_read_u16 v74, v204 offset:31232
  ds_read_u16 v75, v204 offset:31488
  ds_read_u16 v76, v204 offset:31744
  ds_read_u16 v77, v204 offset:32000
  ds_read_u16 v78, v204 offset:32256
  ds_read_u16 v79, v204 offset:32512
  s_waitcnt lgkmcnt(0)
  v_lshl_or_b32 v176, v73, 16, v72
  v_lshl_or_b32 v177, v75, 16, v74
  v_lshl_or_b32 v178, v77, 16, v76
  v_lshl_or_b32 v179, v79, 16, v78
  ds_read_u16 v80, v204 offset:38912
  ds_read_u16 v81, v204 offset:39168
  ds_read_u16 v82, v204 offset:39424
  ds_read_u16 v83, v204 offset:39680
  ds_read_u16 v84, v204 offset:39936
  ds_read_u16 v85, v204 offset:40192
  ds_read_u16 v86, v204 offset:40448
  ds_read_u16 v87, v204 offset:40704
  s_waitcnt lgkmcnt(0)
  v_lshl_or_b32 v180, v81, 16, v80
  v_lshl_or_b32 v181, v83, 16, v82
  v_lshl_or_b32 v182, v85, 16, v84
  v_lshl_or_b32 v183, v87, 16, v86
  ds_read_u16 v88, v204 offset:47104
  ds_read_u16 v89, v204 offset:47360
  ds_read_u16 v90, v204 offset:47616
  ds_read_u16 v91, v204 offset:47872
  ds_read_u16 v92, v204 offset:48128
  ds_read_u16 v93, v204 offset:48384
  ds_read_u16 v94, v204 offset:48640
  ds_read_u16 v95, v204 offset:48896
  s_waitcnt lgkmcnt(0)
  v_lshl_or_b32 v184, v89, 16, v88
  v_lshl_or_b32 v185, v91, 16, v90
  v_lshl_or_b32 v186, v93, 16, v92
  v_lshl_or_b32 v187, v95, 16, v94
  ds_read_u16 v64, v204 offset:22560
  ds_read_u16 v65, v204 offset:22816
  ds_read_u16 v66, v204 offset:23072
  ds_read_u16 v67, v204 offset:23328
  ds_read_u16 v68, v204 offset:23584
  ds_read_u16 v69, v204 offset:23840
  ds_read_u16 v70, v204 offset:24096
  ds_read_u16 v71, v204 offset:24352
  s_waitcnt lgkmcnt(0)
  v_lshl_or_b32 v188, v65, 16, v64
  v_lshl_or_b32 v189, v67, 16, v66
  v_lshl_or_b32 v190, v69, 16, v68
  v_lshl_or_b32 v191, v71, 16, v70
  ds_read_u16 v72, v204 offset:30752
  ds_read_u16 v73, v204 offset:31008
  ds_read_u16 v74, v204 offset:31264
  ds_read_u16 v75, v204 offset:31520
  ds_read_u16 v76, v204 offset:31776
  ds_read_u16 v77, v204 offset:32032
  ds_read_u16 v78, v204 offset:32288
  ds_read_u16 v79, v204 offset:32544
  s_waitcnt lgkmcnt(0)
  v_lshl_or_b32 v192, v73, 16, v72
  v_lshl_or_b32 v193, v75, 16, v74
  v_lshl_or_b32 v194, v77, 16, v76
  v_lshl_or_b32 v195, v79, 16, v78
  ds_read_u16 v80, v204 offset:38944
  ds_read_u16 v81, v204 offset:39200
  ds_read_u16 v82, v204 offset:39456
  ds_read_u16 v83, v204 offset:39712
  ds_read_u16 v84, v204 offset:39968
  ds_read_u16 v85, v204 offset:40224
  ds_read_u16 v86, v204 offset:40480
  ds_read_u16 v87, v204 offset:40736
  s_waitcnt lgkmcnt(0)
  v_lshl_or_b32 v196, v81, 16, v80
  v_lshl_or_b32 v197, v83, 16, v82
  v_lshl_or_b32 v198, v85, 16, v84
  v_lshl_or_b32 v199, v87, 16, v86
  ds_read_u16 v88, v204 offset:47136
  ds_read_u16 v89, v204 offset:47392
  ds_read_u16 v90, v204 offset:47648
  ds_read_u16 v91, v204 offset:47904
  ds_read_u16 v92, v204 offset:48160
  ds_read_u16 v93, v204 offset:48416
  ds_read_u16 v94, v204 offset:48672
  ds_read_u16 v95, v204 offset:48928
  s_waitcnt lgkmcnt(0)
  v_lshl_or_b32 v200, v89, 16, v88
  v_lshl_or_b32 v201, v91, 16, v90
  v_lshl_or_b32 v202, v93, 16, v92
  v_lshl_or_b32 v203, v95, 16, v94
  ds_read_u16 v64, v204 offset:55296
  ds_read_u16 v65, v204 offset:55552
  ds_read_u16 v66, v204 offset:55808
  ds_read_u16 v67, v204 offset:56064
  ds_read_u16 v68, v204 offset:56320
  ds_read_u16 v69, v204 offset:56576
  ds_read_u16 v70, v204 offset:56832
  ds_read_u16 v71, v204 offset:57088
  s_waitcnt lgkmcnt(0)
  v_lshl_or_b32 v208, v65, 16, v64
  v_lshl_or_b32 v209, v67, 16, v66
  v_lshl_or_b32 v210, v69, 16, v68
  v_lshl_or_b32 v211, v71, 16, v70
  ds_read_u16 v72, v204 offset:63488
  ds_read_u16 v73, v204 offset:63744
  ds_read_u16 v74, v204 offset:64000
  ds_read_u16 v75, v204 offset:64256
  ds_read_u16 v76, v204 offset:64512
  ds_read_u16 v77, v204 offset:64768
  ds_read_u16 v78, v204 offset:65024
  ds_read_u16 v79, v204 offset:65280
  s_waitcnt lgkmcnt(0)
  v_lshl_or_b32 v212, v73, 16, v72
  v_lshl_or_b32 v213, v75, 16, v74
  v_lshl_or_b32 v214, v77, 16, v76
  v_lshl_or_b32 v215, v79, 16, v78
  ds_read_u16 v64, v204 offset:55328
  ds_read_u16 v65, v204 offset:55584
  ds_read_u16 v66, v204 offset:55840
  ds_read_u16 v67, v204 offset:56096
  ds_read_u16 v68, v204 offset:56352
  ds_read_u16 v69, v204 offset:56608
  ds_read_u16 v70, v204 offset:56864
  ds_read_u16 v71, v204 offset:57120
  s_waitcnt lgkmcnt(0)
  v_lshl_or_b32 v216, v65, 16, v64
  v_lshl_or_b32 v217, v67, 16, v66
  v_lshl_or_b32 v218, v69, 16, v68
  v_lshl_or_b32 v219, v71, 16, v70
  ds_read_u16 v72, v204 offset:63520
  ds_read_u16 v73, v204 offset:63776
  ds_read_u16 v74, v204 offset:64032
  ds_read_u16 v75, v204 offset:64288
  ds_read_u16 v76, v204 offset:64544
  ds_read_u16 v77, v204 offset:64800
  ds_read_u16 v78, v204 offset:65056
  ds_read_u16 v79, v204 offset:65312
  s_waitcnt lgkmcnt(0)
  v_lshl_or_b32 v220, v73, 16, v72
  v_lshl_or_b32 v221, v75, 16, v74
  v_lshl_or_b32 v222, v77, 16, v76
  v_lshl_or_b32 v223, v79, 16, v78
L_h_notile:
  s_cmp_eq_u32 s45, 3
  s_cbranch_scc1 L_h3
  s_cmp_eq_u32 s45, 0
  s_cbranch_scc0 L_h_ffn2
  s_cmp_lt_u32 s43, 4
  s_cbranch_scc0 L_h_ffn2
L_fflag:
  global_load_dword v153, v3, s[38:39] sc1
  v_and_b32 v154, 16, v1
  v_lshrrev_b32 v154, 1, v154
  s_waitcnt vmcnt(0)
  v_add_u32 v153, v153, v154
  v_cmp_gt_u32 vcc, 8, v153
  s_nop 4
  s_cbranch_vccz L_h_ffn2
  s_sleep 8
  s_cmp_eq_u32 s83, 0
  s_cbranch_scc1 L_to_21
  s_sub_u32 s83, s83, 1
  s_branch L_fflag
L_to_21:
  s_branch L_h_ffn2
L_h3:
  s_mov_b32 s60, s28
  s_mov_b32 s61, s29
  s_mov_b32 s62, 2211840
  s_mov_b32 s63, 0x20000
  s_mul_i32 s69, s44, 276480
  s_lshl_b32 s76, s43, 7
  s_add_u32 s69, s69, s76
  s_cmp_lt_u32 s43, 27
  s_cselect_b32 s69, s69, 0x7f000000
  buffer_load_ushort v32, v205, s[60:63], s69 offen nt
  s_add_u32 s69, s69, 3456
  buffer_load_ushort v33, v205, s[60:63], s69 offen nt
  s_add_u32 s69, s69, 3456
  buffer_load_ushort v34, v205, s[60:63], s69 offen nt
  s_add_u32 s69, s69, 3456
  buffer_load_ushort v35, v205, s[60:63], s69 offen nt
  s_add_u32 s69, s69, 3456
  buffer_load_ushort v36, v205, s[60:63], s69 offen nt
  s_add_u32 s69, s69, 3456
  buffer_load_ushort v37, v205, s[60:63], s69 offen nt
  s_add_u32 s69, s69, 3456
  buffer_load_ushort v38, v205, s[60:63], s69 offen nt
  s_add_u32 s69, s69, 3456
  buffer_load_ushort v39, v205, s[60:63], s69 offen nt
  s_add_u32 s69, s69, 3456
  buffer_load_ushort v40, v205, s[60:63], s69 offen nt
  s_add_u32 s69, s69, 3456
  buffer_load_ushort v41, v205, s[60:63], s69 offen nt
  s_add_u32 s69, s69, 3456
  buffer_load_ushort v42, v205, s[60:63], s69 offen nt
  s_add_u32 s69, s69, 3456
  buffer_load_ushort v43, v205, s[60:63], s69 offen nt
  s_add_u32 s69, s69, 3456
  buffer_load_ushort v44, v205, s[60:63], s69 offen nt
  s_add_u32 s69, s69, 3456
  buffer_load_ushort v45, v205, s[60:63], s69 offen nt
  s_add_u32 s69, s69, 3456
  buffer_load_ushort v46, v205, s[60:63], s69 offen nt
  s_add_u32 s69, s69, 3456
  buffer_load_ushort v47, v205, s[60:63], s69 offen nt
  s_add_u32 s69, s69, 3456
  buffer_load_ushort v48, v205, s[60:63], s69 offen nt
  s_add_u32 s69, s69, 3456
  buffer_load_ushort v49, v205, s[60:63], s69 offen nt
  s_add_u32 s69, s69, 3456
  buffer_load_ushort v50, v205, s[60:63], s69 offen nt
  s_add_u32 s69, s69, 3456
  buffer_load_ushort v51, v205, s[60:63], s69 offen nt
  s_add_u32 s69, s69, 3456
  buffer_load_ushort v52, v205, s[60:63], s69 offen nt
  s_add_u32 s69, s69, 3456
  buffer_load_ushort v53, v205, s[60:63], s69 offen nt
  s_add_u32 s69, s69, 3456
  buffer_load_ushort v54, v205, s[60:63], s69 offen nt
  s_add_u32 s69, s69, 3456
  buffer_load_ushort v55, v205, s[60:63], s69 offen nt
  s_add_u32 s69, s69, 3456
  buffer_load_ushort v56, v205, s[60:63], s69 offen nt
  s_add_u32 s69, s69, 3456
  buffer_load_ushort v57, v205, s[60:63], s69 offen nt
  s_add_u32 s69, s69, 3456
  buffer_load_ushort v58, v205, s[60:63], s69 offen nt
  s_add_u32 s69, s69, 3456
  buffer_load_ushort v59, v205, s[60:63], s69 offen nt
  s_add_u32 s69, s69, 3456
  buffer_load_ushort v60, v205, s[60:63], s69 offen nt
  s_add_u32 s69, s69, 3456
  buffer_load_ushort v61, v205, s[60:63], s69 offen nt
  s_add_u32 s69, s69, 3456
  buffer_load_ushort v62, v205, s[60:63], s69 offen nt
  s_add_u32 s69, s69, 3456
  buffer_load_ushort v63, v205, s[60:63], s69 offen nt
  s_add_u32 s69, s69, 3456
  buffer_load_ushort v64, v205, s[60:63], s69 offen nt
  s_add_u32 s69, s69, 3456
  buffer_load_ushort v65, v205, s[60:63], s69 offen nt
  s_add_u32 s69, s69, 3456
  buffer_load_ushort v66, v205, s[60:63], s69 offen nt
  s_add_u32 s69, s69, 3456
  buffer_load_ushort v67, v205, s[60:63], s69 offen nt
  s_add_u32 s69, s69, 3456
  buffer_load_ushort v68, v205, s[60:63], s69 offen nt
  s_add_u32 s69, s69, 3456
  buffer_load_ushort v69, v205, s[60:63], s69 offen nt
  s_add_u32 s69, s69, 3456
  buffer_load_ushort v70, v205, s[60:63], s69 offen nt
  s_add_u32 s69, s69, 3456
  buffer_load_ushort v71, v205, s[60:63], s69 offen nt
  s_add_u32 s69, s69, 3456
  s_waitcnt vmcnt(0)
  buffer_load_ushort v72, v205, s[60:63], s69 offen nt
  s_add_u32 s69, s69, 3456
  buffer_load_ushort v73, v205, s[60:63], s69 offen nt
  s_add_u32 s69, s69, 3456
  buffer_load_ushort v74, v205, s[60:63], s69 offen nt
  s_add_u32 s69, s69, 3456
  buffer_load_ushort v75, v205, s[60:63], s69 offen nt
  s_add_u32 s69, s69, 3456
  buffer_load_ushort v76, v205, s[60:63], s69 offen nt
  s_add_u32 s69, s69, 3456
  buffer_load_ushort v77, v205, s[60:63], s69 offen nt
  s_add_u32 s69, s69, 3456
  buffer_load_ushort v78, v205, s[60:63], s69 offen nt
  s_add_u32 s69, s69, 3456
  buffer_load_ushort v79, v205, s[60:63], s69 offen nt
  s_add_u32 s69, s69, 3456
  buffer_load_ushort v80, v205, s[60:63], s69 offen nt
  s_add_u32 s69, s69, 3456
  buffer_load_ushort v81, v205, s[60:63], s69 offen nt
  s_add_u32 s69, s69, 3456
  buffer_load_ushort v82, v205, s[60:63], s69 offen nt
  s_add_u32 s69, s69, 3456
  buffer_load_ushort v83, v205, s[60:63], s69 offen nt
  s_add_u32 s69, s69, 3456
  buffer_load_ushort v84, v205, s[60:63], s69 offen nt
  s_add_u32 s69, s69, 3456
  buffer_load_ushort v85, v205, s[60:63], s69 offen nt
  s_add_u32 s69, s69, 3456
  buffer_load_ushort v86, v205, s[60:63], s69 offen nt
  s_add_u32 s69, s69, 3456
  buffer_load_ushort v87, v205, s[60:63], s69 offen nt
  s_add_u32 s69, s69, 3456
  buffer_load_ushort v88, v205, s[60:63], s69 offen nt
  s_add_u32 s69, s69, 3456
  buffer_load_ushort v89, v205, s[60:63], s69 offen nt
  s_add_u32 s69, s69, 3456
  buffer_load_ushort v90, v205, s[60:63], s69 offen nt
  s_add_u32 s69, s69, 3456
  buffer_load_ushort v91, v205, s[60:63], s69 offen nt
  s_add_u32 s69, s69, 3456
  buffer_load_ushort v92, v205, s[60:63], s69 offen nt
  s_add_u32 s69, s69, 3456
  buffer_load_ushort v93, v205, s[60:63], s69 offen nt
  s_add_u32 s69, s69, 3456
  buffer_load_ushort v94, v205, s[60:63], s69 offen nt
  s_add_u32 s69, s69, 3456
  buffer_load_ushort v95, v205, s[60:63], s69 offen nt
  s_add_u32 s69, s69, 3456
  buffer_load_ushort v96, v205, s[60:63], s69 offen nt
  s_add_u32 s69, s69, 3456
  buffer_load_ushort v97, v205, s[60:63], s69 offen nt
  s_add_u32 s69, s69, 3456
  buffer_load_ushort v98, v205, s[60:63], s69 offen nt
  s_add_u32 s69, s69, 3456
  buffer_load_ushort v99, v205, s[60:63], s69 offen nt
  s_add_u32 s69, s69, 3456
  buffer_load_ushort v100, v205, s[60:63], s69 offen nt
  s_add_u32 s69, s69, 3456
  buffer_load_ushort v101, v205, s[60:63], s69 offen nt
  s_add_u32 s69, s69, 3456
  buffer_load_ushort v102, v205, s[60:63], s69 offen nt
  s_add_u32 s69, s69, 3456
  buffer_load_ushort v103, v205, s[60:63], s69 offen nt
  s_add_u32 s69, s69, 3456
  buffer_load_ushort v104, v205, s[60:63], s69 offen nt
  s_add_u32 s69, s69, 3456
  buffer_load_ushort v105, v205, s[60:63], s69 offen nt
  s_add_u32 s69, s69, 3456
  buffer_load_ushort v106, v205, s[60:63], s69 offen nt
  s_add_u32 s69, s69, 3456
  buffer_load_ushort v107, v205, s[60:63], s69 offen nt
  s_add_u32 s69, s69, 3456
  buffer_load_ushort v108, v205, s[60:63], s69 offen nt
  s_add_u32 s69, s69, 3456
  buffer_load_ushort v109, v205, s[60:63], s69 offen nt
  s_add_u32 s69, s69, 3456
  buffer_load_ushort v110, v205, s[60:63], s69 offen nt
  s_add_u32 s69, s69, 3456
  buffer_load_ushort v111, v205, s[60:63], s69 offen nt
  s_add_u32 s69, s69, 3456
  s_waitcnt vmcnt(0)
  v_mov_b32 v128, 0
  v_mov_b32 v129, 0
  v_mov_b32 v130, 0
  v_mov_b32 v131, 0
  s_mul_i32 s76, s44, 320
  v_mov_b32 v152, s76
  ds_read_b128 v[112:115], v152 offset:0
  ds_read_b128 v[116:119], v152 offset:2560
  ds_read_b128 v[120:123], v152 offset:5120
  ds_read_b128 v[124:127], v152 offset:7680
  v_lshlrev_b32 v32, 16, v32
  v_lshlrev_b32 v33, 16, v33
  v_lshlrev_b32 v34, 16, v34
  v_lshlrev_b32 v35, 16, v35
  s_waitcnt lgkmcnt(0)
  v_fmac_f32 v128, v112, v32
  v_fmac_f32 v129, v116, v32
  v_fmac_f32 v130, v120, v32
  v_fmac_f32 v131, v124, v32
  v_fmac_f32 v128, v113, v33
  v_fmac_f32 v129, v117, v33
  v_fmac_f32 v130, v121, v33
  v_fmac_f32 v131, v125, v33
  v_fmac_f32 v128, v114, v34
  v_fmac_f32 v129, v118, v34
  v_fmac_f32 v130, v122, v34
  v_fmac_f32 v131, v126, v34
  v_fmac_f32 v128, v115, v35
  v_fmac_f32 v129, v119, v35
  v_fmac_f32 v130, v123, v35
  v_fmac_f32 v131, v127, v35
  ds_read_b128 v[112:115], v152 offset:16
  ds_read_b128 v[116:119], v152 offset:2576
  ds_read_b128 v[120:123], v152 offset:5136
  ds_read_b128 v[124:127], v152 offset:7696
  v_lshlrev_b32 v36, 16, v36
  v_lshlrev_b32 v37, 16, v37
  v_lshlrev_b32 v38, 16, v38
  v_lshlrev_b32 v39, 16, v39
  s_waitcnt lgkmcnt(0)
  v_fmac_f32 v128, v112, v36
  v_fmac_f32 v129, v116, v36
  v_fmac_f32 v130, v120, v36
  v_fmac_f32 v131, v124, v36
  v_fmac_f32 v128, v113, v37
  v_fmac_f32 v129, v117, v37
  v_fmac_f32 v130, v121, v37
  v_fmac_f32 v131, v125, v37
  v_fmac_f32 v128, v114, v38
  v_fmac_f32 v129, v118, v38
  v_fmac_f32 v130, v122, v38
  v_fmac_f32 v131, v126, v38
  v_fmac_f32 v128, v115, v39
  v_fmac_f32 v129, v119, v39
  v_fmac_f32 v130, v123, v39
  v_fmac_f32 v131, v127, v39
  ds_read_b128 v[112:115], v152 offset:32
  ds_read_b128 v[116:119], v152 offset:2592
  ds_read_b128 v[120:123], v152 offset:5152
  ds_read_b128 v[124:127], v152 offset:7712
  v_lshlrev_b32 v40, 16, v40
  v_lshlrev_b32 v41, 16, v41
  v_lshlrev_b32 v42, 16, v42
  v_lshlrev_b32 v43, 16, v43
  s_waitcnt lgkmcnt(0)
  v_fmac_f32 v128, v112, v40
  v_fmac_f32 v129, v116, v40
  v_fmac_f32 v130, v120, v40
  v_fmac_f32 v131, v124, v40
  v_fmac_f32 v128, v113, v41
  v_fmac_f32 v129, v117, v41
  v_fmac_f32 v130, v121, v41
  v_fmac_f32 v131, v125, v41
  v_fmac_f32 v128, v114, v42
  v_fmac_f32 v129, v118, v42
  v_fmac_f32 v130, v122, v42
  v_fmac_f32 v131, v126, v42
  v_fmac_f32 v128, v115, v43
  v_fmac_f32 v129, v119, v43
  v_fmac_f32 v130, v123, v43
  v_fmac_f32 v131, v127, v43
  ds_read_b128 v[112:115], v152 offset:48
  ds_read_b128 v[116:119], v152 offset:2608
  ds_read_b128 v[120:123], v152 offset:5168
  ds_read_b128 v[124:127], v152 offset:7728
  v_lshlrev_b32 v44, 16, v44
  v_lshlrev_b32 v45, 16, v45
  v_lshlrev_b32 v46, 16, v46
  v_lshlrev_b32 v47, 16, v47
  s_waitcnt lgkmcnt(0)
  v_fmac_f32 v128, v112, v44
  v_fmac_f32 v129, v116, v44
  v_fmac_f32 v130, v120, v44
  v_fmac_f32 v131, v124, v44
  v_fmac_f32 v128, v113, v45
  v_fmac_f32 v129, v117, v45
  v_fmac_f32 v130, v121, v45
  v_fmac_f32 v131, v125, v45
  v_fmac_f32 v128, v114, v46
  v_fmac_f32 v129, v118, v46
  v_fmac_f32 v130, v122, v46
  v_fmac_f32 v131, v126, v46
  v_fmac_f32 v128, v115, v47
  v_fmac_f32 v129, v119, v47
  v_fmac_f32 v130, v123, v47
  v_fmac_f32 v131, v127, v47
  ds_read_b128 v[112:115], v152 offset:64
  ds_read_b128 v[116:119], v152 offset:2624
  ds_read_b128 v[120:123], v152 offset:5184
  ds_read_b128 v[124:127], v152 offset:7744
  v_lshlrev_b32 v48, 16, v48
  v_lshlrev_b32 v49, 16, v49
  v_lshlrev_b32 v50, 16, v50
  v_lshlrev_b32 v51, 16, v51
  s_waitcnt lgkmcnt(0)
  v_fmac_f32 v128, v112, v48
  v_fmac_f32 v129, v116, v48
  v_fmac_f32 v130, v120, v48
  v_fmac_f32 v131, v124, v48
  v_fmac_f32 v128, v113, v49
  v_fmac_f32 v129, v117, v49
  v_fmac_f32 v130, v121, v49
  v_fmac_f32 v131, v125, v49
  v_fmac_f32 v128, v114, v50
  v_fmac_f32 v129, v118, v50
  v_fmac_f32 v130, v122, v50
  v_fmac_f32 v131, v126, v50
  v_fmac_f32 v128, v115, v51
  v_fmac_f32 v129, v119, v51
  v_fmac_f32 v130, v123, v51
  v_fmac_f32 v131, v127, v51
  ds_read_b128 v[112:115], v152 offset:80
  ds_read_b128 v[116:119], v152 offset:2640
  ds_read_b128 v[120:123], v152 offset:5200
  ds_read_b128 v[124:127], v152 offset:7760
  v_lshlrev_b32 v52, 16, v52
  v_lshlrev_b32 v53, 16, v53
  v_lshlrev_b32 v54, 16, v54
  v_lshlrev_b32 v55, 16, v55
  s_waitcnt lgkmcnt(0)
  v_fmac_f32 v128, v112, v52
  v_fmac_f32 v129, v116, v52
  v_fmac_f32 v130, v120, v52
  v_fmac_f32 v131, v124, v52
  v_fmac_f32 v128, v113, v53
  v_fmac_f32 v129, v117, v53
  v_fmac_f32 v130, v121, v53
  v_fmac_f32 v131, v125, v53
  v_fmac_f32 v128, v114, v54
  v_fmac_f32 v129, v118, v54
  v_fmac_f32 v130, v122, v54
  v_fmac_f32 v131, v126, v54
  v_fmac_f32 v128, v115, v55
  v_fmac_f32 v129, v119, v55
  v_fmac_f32 v130, v123, v55
  v_fmac_f32 v131, v127, v55
  ds_read_b128 v[112:115], v152 offset:96
  ds_read_b128 v[116:119], v152 offset:2656
  ds_read_b128 v[120:123], v152 offset:5216
  ds_read_b128 v[124:127], v152 offset:7776
  v_lshlrev_b32 v56, 16, v56
  v_lshlrev_b32 v57, 16, v57
  v_lshlrev_b32 v58, 16, v58
  v_lshlrev_b32 v59, 16, v59
  s_waitcnt lgkmcnt(0)
  v_fmac_f32 v128, v112, v56
  v_fmac_f32 v129, v116, v56
  v_fmac_f32 v130, v120, v56
  v_fmac_f32 v131, v124, v56
  v_fmac_f32 v128, v113, v57
  v_fmac_f32 v129, v117, v57
  v_fmac_f32 v130, v121, v57
  v_fmac_f32 v131, v125, v57
  v_fmac_f32 v128, v114, v58
  v_fmac_f32 v129, v118, v58
  v_fmac_f32 v130, v122, v58
  v_fmac_f32 v131, v126, v58
  v_fmac_f32 v128, v115, v59
  v_fmac_f32 v129, v119, v59
  v_fmac_f32 v130, v123, v59
  v_fmac_f32 v131, v127, v59
  ds_read_b128 v[112:115], v152 offset:112
  ds_read_b128 v[116:119], v152 offset:2672
  ds_read_b128 v[120:123], v152 offset:5232
  ds_read_b128 v[124:127], v152 offset:7792
  v_lshlrev_b32 v60, 16, v60
  v_lshlrev_b32 v61, 16, v61
  v_lshlrev_b32 v62, 16, v62
  v_lshlrev_b32 v63, 16, v63
  s_waitcnt lgkmcnt(0)
  v_fmac_f32 v128, v112, v60
  v_fmac_f32 v129, v116, v60
  v_fmac_f32 v130, v120, v60
  v_fmac_f32 v131, v124, v60
  v_fmac_f32 v128, v113, v61
  v_fmac_f32 v129, v117, v61
  v_fmac_f32 v130, v121, v61
  v_fmac_f32 v131, v125, v61
  v_fmac_f32 v128, v114, v62
  v_fmac_f32 v129, v118, v62
  v_fmac_f32 v130, v122, v62
  v_fmac_f32 v131, v126, v62
  v_fmac_f32 v128, v115, v63
  v_fmac_f32 v129, v119, v63
  v_fmac_f32 v130, v123, v63
  v_fmac_f32 v131, v127, v63
  ds_read_b128 v[112:115], v152 offset:128
  ds_read_b128 v[116:119], v152 offset:2688
  ds_read_b128 v[120:123], v152 offset:5248
  ds_read_b128 v[124:127], v152 offset:7808
  v_lshlrev_b32 v64, 16, v64
  v_lshlrev_b32 v65, 16, v65
  v_lshlrev_b32 v66, 16, v66
  v_lshlrev_b32 v67, 16, v67
  s_waitcnt lgkmcnt(0)
  v_fmac_f32 v128, v112, v64
  v_fmac_f32 v129, v116, v64
  v_fmac_f32 v130, v120, v64
  v_fmac_f32 v131, v124, v64
  v_fmac_f32 v128, v113, v65
  v_fmac_f32 v129, v117, v65
  v_fmac_f32 v130, v121, v65
  v_fmac_f32 v131, v125, v65
  v_fmac_f32 v128, v114, v66
  v_fmac_f32 v129, v118, v66
  v_fmac_f32 v130, v122, v66
  v_fmac_f32 v131, v126, v66
  v_fmac_f32 v128, v115, v67
  v_fmac_f32 v129, v119, v67
  v_fmac_f32 v130, v123, v67
  v_fmac_f32 v131, v127, v67
  ds_read_b128 v[112:115], v152 offset:144
  ds_read_b128 v[116:119], v152 offset:2704
  ds_read_b128 v[120:123], v152 offset:5264
  ds_read_b128 v[124:127], v152 offset:7824
  v_lshlrev_b32 v68, 16, v68
  v_lshlrev_b32 v69, 16, v69
  v_lshlrev_b32 v70, 16, v70
  v_lshlrev_b32 v71, 16, v71
  s_waitcnt lgkmcnt(0)
  v_fmac_f32 v128, v112, v68
  v_fmac_f32 v129, v116, v68
  v_fmac_f32 v130, v120, v68
  v_fmac_f32 v131, v124, v68
  v_fmac_f32 v128, v113, v69
  v_fmac_f32 v129, v117, v69
  v_fmac_f32 v130, v121, v69
  v_fmac_f32 v131, v125, v69
  v_fmac_f32 v128, v114, v70
  v_fmac_f32 v129, v118, v70
  v_fmac_f32 v130, v122, v70
  v_fmac_f32 v131, v126, v70
  v_fmac_f32 v128, v115, v71
  v_fmac_f32 v129, v119, v71
  v_fmac_f32 v130, v123, v71
  v_fmac_f32 v131, v127, v71
  ds_read_b128 v[112:115], v152 offset:160
  ds_read_b128 v[116:119], v152 offset:2720
  ds_read_b128 v[120:123], v152 offset:5280
  ds_read_b128 v[124:127], v152 offset:7840
  v_lshlrev_b32 v72, 16, v72
  v_lshlrev_b32 v73, 16, v73
  v_lshlrev_b32 v74, 16, v74
  v_lshlrev_b32 v75, 16, v75
  s_waitcnt lgkmcnt(0)
  v_fmac_f32 v128, v112, v72
  v_fmac_f32 v129, v116, v72
  v_fmac_f32 v130, v120, v72
  v_fmac_f32 v131, v124, v72
  v_fmac_f32 v128, v113, v73
  v_fmac_f32 v129, v117, v73
  v_fmac_f32 v130, v121, v73
  v_fmac_f32 v131, v125, v73
  v_fmac_f32 v128, v114, v74
  v_fmac_f32 v129, v118, v74
  v_fmac_f32 v130, v122, v74
  v_fmac_f32 v131, v126, v74
  v_fmac_f32 v128, v115, v75
  v_fmac_f32 v129, v119, v75
  v_fmac_f32 v130, v123, v75
  v_fmac_f32 v131, v127, v75
  ds_read_b128 v[112:115], v152 offset:176
  ds_read_b128 v[116:119], v152 offset:2736
  ds_read_b128 v[120:123], v152 offset:5296
  ds_read_b128 v[124:127], v152 offset:7856
  v_lshlrev_b32 v76, 16, v76
  v_lshlrev_b32 v77, 16, v77
  v_lshlrev_b32 v78, 16, v78
  v_lshlrev_b32 v79, 16, v79
  s_waitcnt lgkmcnt(0)
  v_fmac_f32 v128, v112, v76
  v_fmac_f32 v129, v116, v76
  v_fmac_f32 v130, v120, v76
  v_fmac_f32 v131, v124, v76
  v_fmac_f32 v128, v113, v77
  v_fmac_f32 v129, v117, v77
  v_fmac_f32 v130, v121, v77
  v_fmac_f32 v131, v125, v77
  v_fmac_f32 v128, v114, v78
  v_fmac_f32 v129, v118, v78
  v_fmac_f32 v130, v122, v78
  v_fmac_f32 v131, v126, v78
  v_fmac_f32 v128, v115, v79
  v_fmac_f32 v129, v119, v79
  v_fmac_f32 v130, v123, v79
  v_fmac_f32 v131, v127, v79
  ds_read_b128 v[112:115], v152 offset:192
  ds_read_b128 v[116:119], v152 offset:2752
  ds_read_b128 v[120:123], v152 offset:5312
  ds_read_b128 v[124:127], v152 offset:7872
  v_lshlrev_b32 v80, 16, v80
  v_lshlrev_b32 v81, 16, v81
  v_lshlrev_b32 v82, 16, v82
  v_lshlrev_b32 v83, 16, v83
  s_waitcnt lgkmcnt(0)
  v_fmac_f32 v128, v112, v80
  v_fmac_f32 v129, v116, v80
  v_fmac_f32 v130, v120, v80
  v_fmac_f32 v131, v124, v80
  v_fmac_f32 v128, v113, v81
  v_fmac_f32 v129, v117, v81
  v_fmac_f32 v130, v121, v81
  v_fmac_f32 v131, v125, v81
  v_fmac_f32 v128, v114, v82
  v_fmac_f32 v129, v118, v82
  v_fmac_f32 v130, v122, v82
  v_fmac_f32 v131, v126, v82
  v_fmac_f32 v128, v115, v83
  v_fmac_f32 v129, v119, v83
  v_fmac_f32 v130, v123, v83
  v_fmac_f32 v131, v127, v83
  ds_read_b128 v[112:115], v152 offset:208
  ds_read_b128 v[116:119], v152 offset:2768
  ds_read_b128 v[120:123], v152 offset:5328
  ds_read_b128 v[124:127], v152 offset:7888
  v_lshlrev_b32 v84, 16, v84
  v_lshlrev_b32 v85, 16, v85
  v_lshlrev_b32 v86, 16, v86
  v_lshlrev_b32 v87, 16, v87
  s_waitcnt lgkmcnt(0)
  v_fmac_f32 v128, v112, v84
  v_fmac_f32 v129, v116, v84
  v_fmac_f32 v130, v120, v84
  v_fmac_f32 v131, v124, v84
  v_fmac_f32 v128, v113, v85
  v_fmac_f32 v129, v117, v85
  v_fmac_f32 v130, v121, v85
  v_fmac_f32 v131, v125, v85
  v_fmac_f32 v128, v114, v86
  v_fmac_f32 v129, v118, v86
  v_fmac_f32 v130, v122, v86
  v_fmac_f32 v131, v126, v86
  v_fmac_f32 v128, v115, v87
  v_fmac_f32 v129, v119, v87
  v_fmac_f32 v130, v123, v87
  v_fmac_f32 v131, v127, v87
  ds_read_b128 v[112:115], v152 offset:224
  ds_read_b128 v[116:119], v152 offset:2784
  ds_read_b128 v[120:123], v152 offset:5344
  ds_read_b128 v[124:127], v152 offset:7904
  v_lshlrev_b32 v88, 16, v88
  v_lshlrev_b32 v89, 16, v89
  v_lshlrev_b32 v90, 16, v90
  v_lshlrev_b32 v91, 16, v91
  s_waitcnt lgkmcnt(0)
  v_fmac_f32 v128, v112, v88
  v_fmac_f32 v129, v116, v88
  v_fmac_f32 v130, v120, v88
  v_fmac_f32 v131, v124, v88
  v_fmac_f32 v128, v113, v89
  v_fmac_f32 v129, v117, v89
  v_fmac_f32 v130, v121, v89
  v_fmac_f32 v131, v125, v89
  v_fmac_f32 v128, v114, v90
  v_fmac_f32 v129, v118, v90
  v_fmac_f32 v130, v122, v90
  v_fmac_f32 v131, v126, v90
  v_fmac_f32 v128, v115, v91
  v_fmac_f32 v129, v119, v91
  v_fmac_f32 v130, v123, v91
  v_fmac_f32 v131, v127, v91
  ds_read_b128 v[112:115], v152 offset:240
  ds_read_b128 v[116:119], v152 offset:2800
  ds_read_b128 v[120:123], v152 offset:5360
  ds_read_b128 v[124:127], v152 offset:7920
  v_lshlrev_b32 v92, 16, v92
  v_lshlrev_b32 v93, 16, v93
  v_lshlrev_b32 v94, 16, v94
  v_lshlrev_b32 v95, 16, v95
  s_waitcnt lgkmcnt(0)
  v_fmac_f32 v128, v112, v92
  v_fmac_f32 v129, v116, v92
  v_fmac_f32 v130, v120, v92
  v_fmac_f32 v131, v124, v92
  v_fmac_f32 v128, v113, v93
  v_fmac_f32 v129, v117, v93
  v_fmac_f32 v130, v121, v93
  v_fmac_f32 v131, v125, v93
  v_fmac_f32 v128, v114, v94
  v_fmac_f32 v129, v118, v94
  v_fmac_f32 v130, v122, v94
  v_fmac_f32 v131, v126, v94
  v_fmac_f32 v128, v115, v95
  v_fmac_f32 v129, v119, v95
  v_fmac_f32 v130, v123, v95
  v_fmac_f32 v131, v127, v95
  ds_read_b128 v[112:115], v152 offset:256
  ds_read_b128 v[116:119], v152 offset:2816
  ds_read_b128 v[120:123], v152 offset:5376
  ds_read_b128 v[124:127], v152 offset:7936
  v_lshlrev_b32 v96, 16, v96
  v_lshlrev_b32 v97, 16, v97
  v_lshlrev_b32 v98, 16, v98
  v_lshlrev_b32 v99, 16, v99
  s_waitcnt lgkmcnt(0)
  v_fmac_f32 v128, v112, v96
  v_fmac_f32 v129, v116, v96
  v_fmac_f32 v130, v120, v96
  v_fmac_f32 v131, v124, v96
  v_fmac_f32 v128, v113, v97
  v_fmac_f32 v129, v117, v97
  v_fmac_f32 v130, v121, v97
  v_fmac_f32 v131, v125, v97
  v_fmac_f32 v128, v114, v98
  v_fmac_f32 v129, v118, v98
  v_fmac_f32 v130, v122, v98
  v_fmac_f32 v131, v126, v98
  v_fmac_f32 v128, v115, v99
  v_fmac_f32 v129, v119, v99
  v_fmac_f32 v130, v123, v99
  v_fmac_f32 v131, v127, v99
  ds_read_b128 v[112:115], v152 offset:272
  ds_read_b128 v[116:119], v152 offset:2832
  ds_read_b128 v[120:123], v152 offset:5392
  ds_read_b128 v[124:127], v152 offset:7952
  v_lshlrev_b32 v100, 16, v100
  v_lshlrev_b32 v101, 16, v101
  v_lshlrev_b32 v102, 16, v102
  v_lshlrev_b32 v103, 16, v103
  s_waitcnt lgkmcnt(0)
  v_fmac_f32 v128, v112, v100
  v_fmac_f32 v129, v116, v100
  v_fmac_f32 v130, v120, v100
  v_fmac_f32 v131, v124, v100
  v_fmac_f32 v128, v113, v101
  v_fmac_f32 v129, v117, v101
  v_fmac_f32 v130, v121, v101
  v_fmac_f32 v131, v125, v101
  v_fmac_f32 v128, v114, v102
  v_fmac_f32 v129, v118, v102
  v_fmac_f32 v130, v122, v102
  v_fmac_f32 v131, v126, v102
  v_fmac_f32 v128, v115, v103
  v_fmac_f32 v129, v119, v103
  v_fmac_f32 v130, v123, v103
  v_fmac_f32 v131, v127, v103
  ds_read_b128 v[112:115], v152 offset:288
  ds_read_b128 v[116:119], v152 offset:2848
  ds_read_b128 v[120:123], v152 offset:5408
  ds_read_b128 v[124:127], v152 offset:7968
  v_lshlrev_b32 v104, 16, v104
  v_lshlrev_b32 v105, 16, v105
  v_lshlrev_b32 v106, 16, v106
  v_lshlrev_b32 v107, 16, v107
  s_waitcnt lgkmcnt(0)
  v_fmac_f32 v128, v112, v104
  v_fmac_f32 v129, v116, v104
  v_fmac_f32 v130, v120, v104
  v_fmac_f32 v131, v124, v104
  v_fmac_f32 v128, v113, v105
  v_fmac_f32 v129, v117, v105
  v_fmac_f32 v130, v121, v105
  v_fmac_f32 v131, v125, v105
  v_fmac_f32 v128, v114, v106
  v_fmac_f32 v129, v118, v106
  v_fmac_f32 v130, v122, v106
  v_fmac_f32 v131, v126, v106
  v_fmac_f32 v128, v115, v107
  v_fmac_f32 v129, v119, v107
  v_fmac_f32 v130, v123, v107
  v_fmac_f32 v131, v127, v107
  ds_read_b128 v[112:115], v152 offset:304
  ds_read_b128 v[116:119], v152 offset:2864
  ds_read_b128 v[120:123], v152 offset:5424
  ds_read_b128 v[124:127], v152 offset:7984
  v_lshlrev_b32 v108, 16, v108
  v_lshlrev_b32 v109, 16, v109
  v_lshlrev_b32 v110, 16, v110
  v_lshlrev_b32 v111, 16, v111
  s_waitcnt lgkmcnt(0)
  v_fmac_f32 v128, v112, v108
  v_fmac_f32 v129, v116, v108
  v_fmac_f32 v130, v120, v108
  v_fmac_f32 v131, v124, v108
  v_fmac_f32 v128, v113, v109
  v_fmac_f32 v129, v117, v109
  v_fmac_f32 v130, v121, v109
  v_fmac_f32 v131, v125, v109
  v_fmac_f32 v128, v114, v110
  v_fmac_f32 v129, v118, v110
  v_fmac_f32 v130, v122, v110
  v_fmac_f32 v131, v126, v110
  v_fmac_f32 v128, v115, v111
  v_fmac_f32 v129, v119, v111
  v_fmac_f32 v130, v123, v111
  v_fmac_f32 v131, v127, v111
  s_add_u32 s76, s66, 4096
  v_add_u32 v153, s76, v3
  global_store_dword v153, v128, s[40:41] offset:0 sc1
  global_store_dword v153, v129, s[40:41] offset:256 sc1
  global_store_dword v153, v130, s[40:41] offset:512 sc1
  global_store_dword v153, v131, s[40:41] offset:768 sc1
  s_cmp_lt_u32 s44, 5
  s_cbranch_scc0 L_h_tailprep
  s_mov_b32 s60, s30
  s_mov_b32 s61, s31
  s_mov_b32 s62, 3456
  s_mov_b32 s63, 0x20000
  s_lshl_b32 s76, s43, 7
  buffer_load_ushort v155, v205, s[60:63], s76 offen
  s_add_u32 s76, s65, 4096
  v_add_u32 v112, s76, v3
  s_add_u32 s76, s65, 12288
  v_add_u32 v113, s76, v3
  s_add_u32 s76, s65, 20480
  v_add_u32 v114, s76, v3
  s_add_u32 s76, s65, 28672
  v_add_u32 v115, s76, v3
  s_add_u32 s76, s65, 36864
  v_add_u32 v116, s76, v3
  s_add_u32 s76, s65, 45056
  v_add_u32 v117, s76, v3
  s_add_u32 s76, s65, 53248
  v_add_u32 v118, s76, v3
  s_add_u32 s76, s65, 61440
  v_add_u32 v119, s76, v3
  v_and_b32 v157, 7, v1
  v_lshlrev_b32 v157, 13, v157
  s_add_u32 s76, s65, 4864
  v_add_u32 v157, s76, v157
  s_mov_b64 exec, 0xff
L_hlp:
  global_load_dword v158, v157, s[40:41] sc1
  s_waitcnt vmcnt(0)
  v_cmp_eq_u32 vcc, -1, v158
  s_nop 4
  s_cbranch_vccz L_hlpok
  s_sleep 32
  s_cmp_eq_u32 s83, 0
  s_cbranch_scc1 L_to_22
  s_sub_u32 s83, s83, 1
  s_branch L_hlp
L_to_22:
L_hlpok:
  s_mov_b64 exec, -1
L_hg:
  global_load_dword v32, v112, s[40:41] offset:0 sc1
  global_load_dword v33, v113, s[40:41] offset:0 sc1
  global_load_dword v34, v114, s[40:41] offset:0 sc1
  global_load_dword v35, v115, s[40:41] offset:0 sc1
  global_load_dword v36, v116, s[40:41] offset:0 sc1
  global_load_dword v37, v117, s[40:41] offset:0 sc1
  global_load_dword v38, v118, s[40:41] offset:0 sc1
  global_load_dword v39, v119, s[40:41] offset:0 sc1
  global_load_dword v40, v112, s[40:41] offset:256 sc1
  global_load_dword v41, v113, s[40:41] offset:256 sc1
  global_load_dword v42, v114, s[40:41] offset:256 sc1
  global_load_dword v43, v115, s[40:41] offset:256 sc1
  global_load_dword v44, v116, s[40:41] offset:256 sc1
  global_load_dword v45, v117, s[40:41] offset:256 sc1
  global_load_dword v46, v118, s[40:41] offset:256 sc1
  global_load_dword v47, v119, s[40:41] offset:256 sc1
  global_load_dword v48, v112, s[40:41] offset:512 sc1
  global_load_dword v49, v113, s[40:41] offset:512 sc1
  global_load_dword v50, v114, s[40:41] offset:512 sc1
  global_load_dword v51, v115, s[40:41] offset:512 sc1
  global_load_dword v52, v116, s[40:41] offset:512 sc1
  global_load_dword v53, v117, s[40:41] offset:512 sc1
  global_load_dword v54, v118, s[40:41] offset:512 sc1
  global_load_dword v55, v119, s[40:41] offset:512 sc1
  global_load_dword v56, v112, s[40:41] offset:768 sc1
  global_load_dword v57, v113, s[40:41] offset:768 sc1
  global_load_dword v58, v114, s[40:41] offset:768 sc1
  global_load_dword v59, v115, s[40:41] offset:768 sc1
  global_load_dword v60, v116, s[40:41] offset:768 sc1
  global_load_dword v61, v117, s[40:41] offset:768 sc1
  global_load_dword v62, v118, s[40:41] offset:768 sc1
  global_load_dword v63, v119, s[40:41] offset:768 sc1
  s_waitcnt vmcnt(0)
  v_max3_u32 v156, v32, v33, v34
  v_max3_u32 v156, v156, v35, v36
  v_max3_u32 v156, v156, v37, v38
  v_max3_u32 v156, v156, v39, v40
  v_max3_u32 v156, v156, v41, v42
  v_max3_u32 v156, v156, v43, v44
  v_max3_u32 v156, v156, v45, v46
  v_max3_u32 v156, v156, v47, v48
  v_max3_u32 v156, v156, v49, v50
  v_max3_u32 v156, v156, v51, v52
  v_max3_u32 v156, v156, v53, v54
  v_max3_u32 v156, v156, v55, v56
  v_max3_u32 v156, v156, v57, v58
  v_max3_u32 v156, v156, v59, v60
  v_max3_u32 v156, v156, v61, v62
  v_max_u32 v156, v156, v63
  v_cmp_eq_u32 vcc, -1, v156
  s_nop 4
  s_cbranch_vccz L_hgok
  s_sleep 16
  s_cmp_eq_u32 s83, 0
  s_cbranch_scc1 L_to_23
  s_sub_u32 s83, s83, 1
  s_branch L_hg
L_to_23:
L_hgok:
  v_lshlrev_b32 v155, 16, v155
  v_add_f32 v32, v32, v33
  v_add_f32 v32, v32, v34
  v_add_f32 v32, v32, v35
  v_add_f32 v32, v32, v36
  v_add_f32 v32, v32, v37
  v_add_f32 v32, v32, v38
  v_add_f32 v32, v32, v39
  v_cvt_pk_bf16_f32 v32, v32, v32
  v_and_b32 v32, s46, v32
  v_add_f32 v32, v32, v155
  v_cvt_pk_bf16_f32 v32, v32, v32
  v_and_b32 v32, s46, v32
  v_max_f32 v32, 0, v32
  v_mul_f32 v32, v32, v32
  v_cvt_pk_bf16_f32 v32, v32, v32
  ds_write_b16 v205, v32 offset:19456
  v_add_f32 v40, v40, v41
  v_add_f32 v40, v40, v42
  v_add_f32 v40, v40, v43
  v_add_f32 v40, v40, v44
  v_add_f32 v40, v40, v45
  v_add_f32 v40, v40, v46
  v_add_f32 v40, v40, v47
  v_cvt_pk_bf16_f32 v40, v40, v40
  v_and_b32 v40, s46, v40
  v_add_f32 v40, v40, v155
  v_cvt_pk_bf16_f32 v40, v40, v40
  v_and_b32 v40, s46, v40
  v_max_f32 v40, 0, v40
  v_mul_f32 v40, v40, v40
  v_cvt_pk_bf16_f32 v40, v40, v40
  ds_write_b16 v205, v40 offset:19584
  v_add_f32 v48, v48, v49
  v_add_f32 v48, v48, v50
  v_add_f32 v48, v48, v51
  v_add_f32 v48, v48, v52
  v_add_f32 v48, v48, v53
  v_add_f32 v48, v48, v54
  v_add_f32 v48, v48, v55
  v_cvt_pk_bf16_f32 v48, v48, v48
  v_and_b32 v48, s46, v48
  v_add_f32 v48, v48, v155
  v_cvt_pk_bf16_f32 v48, v48, v48
  v_and_b32 v48, s46, v48
  v_max_f32 v48, 0, v48
  v_mul_f32 v48, v48, v48
  v_cvt_pk_bf16_f32 v48, v48, v48
  ds_write_b16 v205, v48 offset:19712
  v_add_f32 v56, v56, v57
  v_add_f32 v56, v56, v58
  v_add_f32 v56, v56, v59
  v_add_f32 v56, v56, v60
  v_add_f32 v56, v56, v61
  v_add_f32 v56, v56, v62
  v_add_f32 v56, v56, v63
  v_cvt_pk_bf16_f32 v56, v56, v56
  v_and_b32 v56, s46, v56
  v_add_f32 v56, v56, v155
  v_cvt_pk_bf16_f32 v56, v56, v56
  v_and_b32 v56, s46, v56
  v_max_f32 v56, 0, v56
  v_mul_f32 v56, v56, v56
  v_cvt_pk_bf16_f32 v56, v56, v56
  ds_write_b16 v205, v56 offset:19840
  s_mov_b64 exec, 1
  ds_add_u32 v6, v7 offset:28
  s_mov_b64 exec, -1
L_h_ffn2:
  s_cmp_lt_u32 s44, 5
  s_cbranch_scc0 L_h_tailprep
L_lw_24:
  ds_read_b32 v156, v6 offset:28
  s_waitcnt lgkmcnt(0)
  v_readfirstlane_b32 s76, v156
  s_nop 1
  s_cmp_ge_u32 s76, 1
  s_cbranch_scc1 L_lwok_25
  s_sleep 32
  s_cmp_eq_u32 s83, 0
  s_cbranch_scc1 L_to_26
  s_sub_u32 s83, s83, 1
  s_branch L_lw_24
L_to_26:
L_lwok_25:
  v_and_b32 v152, 3, v1
  v_lshlrev_b32 v152, 7, v152
  v_lshrrev_b32 v153, 4, v1
  v_lshlrev_b32 v153, 4, v153
  v_add_u32 v152, v152, v153
  ds_read_b128 v[132:135], v152 offset:19456
  ds_read_b128 v[136:139], v152 offset:19520
  v_mov_b32 v224, 0
  v_mov_b32 v225, 0
  v_mov_b32 v226, 0
  v_mov_b32 v227, 0
  v_mov_b32 v228, 0
  v_mov_b32 v229, 0
  v_mov_b32 v230, 0
  v_mov_b32 v231, 0
  s_waitcnt lgkmcnt(0)
  v_mfma_f32_16x16x32_bf16 v[224:227], v[132:135], v[208:211], v[224:227]
  v_mfma_f32_16x16x32_bf16 v[228:231], v[132:135], v[216:219], v[228:231]
  v_mfma_f32_16x16x32_bf16 v[224:227], v[136:139], v[212:215], v[224:227]
  v_mfma_f32_16x16x32_bf16 v[228:231], v[136:139], v[220:223], v[228:231]
L_h_tailprep:
  s_lshl_b32 s76, s45, 11
  s_add_u32 s76, s76, 88064
  v_lshlrev_b32 v38, 3, v1
  v_add_u32 v8, s76, v38
  v_add_u32 v9, 32768, v8
  v_and_b32 v39, 15, v1
  v_lshlrev_b32 v10, 3, v39
  s_lshl_b32 s76, s45, 7
  v_add_u32 v10, s76, v10
  s_lshl_b32 s76, s45, 9
  s_add_u32 s77, s66, s76
  s_add_u32 s77, s77, 2048
  v_add_u32 v11, s77, v38
  s_add_u32 s77, s65, s76
  s_add_u32 s78, s77, 2048
  v_add_u32 v20, s78, v38
  s_add_u32 s78, s77, 10240
  v_add_u32 v21, s78, v38
  s_add_u32 s78, s77, 18432
  v_add_u32 v22, s78, v38
  s_add_u32 s78, s77, 26624
  v_add_u32 v23, s78, v38
  s_add_u32 s78, s77, 34816
  v_add_u32 v24, s78, v38
  s_add_u32 s78, s77, 43008
  v_add_u32 v25, s78, v38
  s_add_u32 s78, s77, 51200
  v_add_u32 v26, s78, v38
  s_add_u32 s78, s77, 59392
  v_add_u32 v27, s78, v38
  v_and_b32 v40, 7, v1
  s_lshl_b32 s76, s43, 2
  s_add_u32 s76, s76, s45
  s_lshl_b32 s77, s76, 6
  s_add_u32 s77, s77, 65536
  s_lshl_b32 s78, s44, 3
  s_add_u32 s78, s78, s77
  v_mov_b32 v12, s78
  v_lshlrev_b32 v13, 3, v40
  v_add_u32 v13, s77, v13
  v_lshlrev_b32 v14, 13, v40
  s_add_u32 s78, s65, 7168
  v_add_u32 v14, s78, v14
  s_add_u32 s78, s66, 7168
  v_mov_b32 v15, s78
  s_lshl_b32 s76, s45, 8
  v_add_u32 v16, s76, v3
  v_and_b32 v17, 3, v1
  v_lshlrev_b32 v17, 8, v17
  v_lshrrev_b32 v40, 4, v1
  v_lshlrev_b32 v40, 4, v40
  v_add_u32 v17, v17, v40
  v_lshlrev_b32 v18, 2, v39
  s_lshl_b32 s76, s45, 7
  s_add_u32 s76, s76, s66
  s_add_u32 s76, s76, 5120
  v_add_u32 v18, s76, v18
  s_mov_b32 s83, 262144
  s_waitcnt vmcnt(0) lgkmcnt(0)
  s_barrier
  ds_read_b64 v[28:29], v10 offset:21248
  ds_read_b64 v[64:65], v8 offset:0
  ds_read_b64 v[66:67], v8 offset:512
  ds_read_b64 v[68:69], v8 offset:1024
  ds_read_b64 v[70:71], v8 offset:1536
  ds_read_b64 v[72:73], v8 offset:16384
  ds_read_b64 v[74:75], v8 offset:16896
  ds_read_b64 v[76:77], v8 offset:17408
  ds_read_b64 v[78:79], v8 offset:17920
  ds_read_b64 v[80:81], v9 offset:0
  ds_read_b64 v[82:83], v9 offset:512
  ds_read_b64 v[84:85], v9 offset:1024
  ds_read_b64 v[86:87], v9 offset:1536
  ds_read_b64 v[88:89], v9 offset:16384
  ds_read_b64 v[90:91], v9 offset:16896
  s_waitcnt lgkmcnt(14)
  ds_read_b64 v[92:93], v9 offset:17408
  ds_read_b64 v[94:95], v9 offset:17920
  v_mov_b32 v32, v28
  s_nop 1
  v_max_f32_dpp v32, v32, v32 quad_perm:[1,0,3,2] row_mask:0xf bank_mask:0xf
  s_nop 1
  v_max_f32_dpp v32, v32, v32 quad_perm:[2,3,0,1] row_mask:0xf bank_mask:0xf
  s_nop 1
  v_max_f32_dpp v32, v32, v32 row_half_mirror row_mask:0xf bank_mask:0xf
  s_nop 1
  v_max_f32_dpp v32, v32, v32 row_mirror row_mask:0xf bank_mask:0xf
  v_sub_f32 v30, v28, v32
  v_exp_f32 v30, v30
  s_nop 0
  v_mul_f32 v31, v30, v29
  s_nop 1
  v_add_f32_dpp v31, v31, v31 quad_perm:[1,0,3,2] row_mask:0xf bank_mask:0xf
  s_nop 1
  v_add_f32_dpp v31, v31, v31 quad_perm:[2,3,0,1] row_mask:0xf bank_mask:0xf
  s_nop 1
  v_add_f32_dpp v31, v31, v31 row_half_mirror row_mask:0xf bank_mask:0xf
  s_nop 1
  v_add_f32_dpp v31, v31, v31 row_mirror row_mask:0xf bank_mask:0xf
  s_waitcnt lgkmcnt(0)
  v_mov_b32 v34, 0
  v_mov_b32 v35, 0
  v_mov_b32 v36, 0
  v_mov_b32 v37, 0
  v_fmac_f32_dpp v34, v30, v64 row_newbcast:0 row_mask:0xf bank_mask:0xf
  v_fmac_f32_dpp v35, v30, v65 row_newbcast:0 row_mask:0xf bank_mask:0xf
  v_fmac_f32_dpp v36, v30, v66 row_newbcast:1 row_mask:0xf bank_mask:0xf
  v_fmac_f32_dpp v37, v30, v67 row_newbcast:1 row_mask:0xf bank_mask:0xf
  v_fmac_f32_dpp v34, v30, v68 row_newbcast:2 row_mask:0xf bank_mask:0xf
  v_fmac_f32_dpp v35, v30, v69 row_newbcast:2 row_mask:0xf bank_mask:0xf
  v_fmac_f32_dpp v36, v30, v70 row_newbcast:3 row_mask:0xf bank_mask:0xf
  v_fmac_f32_dpp v37, v30, v71 row_newbcast:3 row_mask:0xf bank_mask:0xf
  v_fmac_f32_dpp v34, v30, v72 row_newbcast:4 row_mask:0xf bank_mask:0xf
  v_fmac_f32_dpp v35, v30, v73 row_newbcast:4 row_mask:0xf bank_mask:0xf
  v_fmac_f32_dpp v36, v30, v74 row_newbcast:5 row_mask:0xf bank_mask:0xf
  v_fmac_f32_dpp v37, v30, v75 row_newbcast:5 row_mask:0xf bank_mask:0xf
  v_fmac_f32_dpp v34, v30, v76 row_newbcast:6 row_mask:0xf bank_mask:0xf
  v_fmac_f32_dpp v35, v30, v77 row_newbcast:6 row_mask:0xf bank_mask:0xf
  v_fmac_f32_dpp v36, v30, v78 row_newbcast:7 row_mask:0xf bank_mask:0xf
  v_fmac_f32_dpp v37, v30, v79 row_newbcast:7 row_mask:0xf bank_mask:0xf
  v_fmac_f32_dpp v34, v30, v80 row_newbcast:8 row_mask:0xf bank_mask:0xf
  v_fmac_f32_dpp v35, v30, v81 row_newbcast:8 row_mask:0xf bank_mask:0xf
  v_fmac_f32_dpp v36, v30, v82 row_newbcast:9 row_mask:0xf bank_mask:0xf
  v_fmac_f32_dpp v37, v30, v83 row_newbcast:9 row_mask:0xf bank_mask:0xf
  v_fmac_f32_dpp v34, v30, v84 row_newbcast:10 row_mask:0xf bank_mask:0xf
  v_fmac_f32_dpp v35, v30, v85 row_newbcast:10 row_mask:0xf bank_mask:0xf
  v_fmac_f32_dpp v36, v30, v86 row_newbcast:11 row_mask:0xf bank_mask:0xf
  v_fmac_f32_dpp v37, v30, v87 row_newbcast:11 row_mask:0xf bank_mask:0xf
  v_fmac_f32_dpp v34, v30, v88 row_newbcast:12 row_mask:0xf bank_mask:0xf
  v_fmac_f32_dpp v35, v30, v89 row_newbcast:12 row_mask:0xf bank_mask:0xf
  v_fmac_f32_dpp v36, v30, v90 row_newbcast:13 row_mask:0xf bank_mask:0xf
  v_fmac_f32_dpp v37, v30, v91 row_newbcast:13 row_mask:0xf bank_mask:0xf
  v_fmac_f32_dpp v34, v30, v92 row_newbcast:14 row_mask:0xf bank_mask:0xf
  v_fmac_f32_dpp v35, v30, v93 row_newbcast:14 row_mask:0xf bank_mask:0xf
  v_fmac_f32_dpp v36, v30, v94 row_newbcast:15 row_mask:0xf bank_mask:0xf
  v_fmac_f32_dpp v37, v30, v95 row_newbcast:15 row_mask:0xf bank_mask:0xf
  v_pk_add_f32 v[34:35], v[34:35], v[36:37]
  global_store_dwordx2 v11, v[34:35], s[40:41] sc1
  v_mov_b32 v40, v32
  v_mov_b32 v41, v31
  s_mov_b64 exec, 1
  global_store_dwordx2 v12, v[40:41], s[40:41] sc1
  s_mov_b64 exec, -1
  s_cmp_lt_u32 s44, 5
  s_cbranch_scc0 L_fin_stamp
  s_mov_b32 s6, 0xff
  s_mov_b32 s76, 0
L_opoll:
  global_load_dwordx2 v[28:29], v13, s[40:41] sc1
  s_bitcmp1_b32 s6, 0
  s_cbranch_scc0 L_sk0
  global_load_dwordx2 v[64:65], v20, s[40:41] sc1
L_sk0:
  s_bitcmp1_b32 s6, 1
  s_cbranch_scc0 L_sk1
  global_load_dwordx2 v[66:67], v21, s[40:41] sc1
L_sk1:
  s_bitcmp1_b32 s6, 2
  s_cbranch_scc0 L_sk2
  global_load_dwordx2 v[68:69], v22, s[40:41] sc1
L_sk2:
  s_bitcmp1_b32 s6, 3
  s_cbranch_scc0 L_sk3
  global_load_dwordx2 v[70:71], v23, s[40:41] sc1
L_sk3:
  s_bitcmp1_b32 s6, 4
  s_cbranch_scc0 L_sk4
  global_load_dwordx2 v[72:73], v24, s[40:41] sc1
L_sk4:
  s_bitcmp1_b32 s6, 5
  s_cbranch_scc0 L_sk5
  global_load_dwordx2 v[74:75], v25, s[40:41] sc1
L_sk5:
  s_bitcmp1_b32 s6, 6
  s_cbranch_scc0 L_sk6
  global_load_dwordx2 v[76:77], v26, s[40:41] sc1
L_sk6:
  s_bitcmp1_b32 s6, 7
  s_cbranch_scc0 L_sk7
  global_load_dwordx2 v[78:79], v27, s[40:41] sc1
L_sk7:
  s_waitcnt vmcnt(0)
  v_max_u32 v40, v28, v29
  v_cmp_eq_u32 vcc, -1, v40
  s_nop 4
  s_mov_b32 s77, s6
  s_and_b32 s6, vcc_lo, 0xff
  s_cbranch_scc1 L_oretry
  v_max3_u32 v40, v64, v65, v66
  v_max3_u32 v40, v40, v67, v68
  v_max3_u32 v40, v40, v69, v70
  v_max3_u32 v40, v40, v71, v72
  v_max3_u32 v40, v40, v73, v74
  v_max3_u32 v40, v40, v75, v76
  v_max3_u32 v40, v40, v77, v78
  v_max_u32 v40, v40, v79
  v_cmp_eq_u32 vcc, -1, v40
  s_nop 4
  s_cbranch_vccz L_ook
  s_xor_b32 s76, s76, 1
  s_cmp_eq_u32 s76, 1
  s_cselect_b32 s6, s77, 0xff
L_oretry:
  s_cmp_eq_u32 s83, 0
  s_cbranch_scc1 L_to_27
  s_sub_u32 s83, s83, 1
  s_branch L_opoll
L_to_27:
L_ook:
  v_mov_b32 v32, v28
  s_nop 1
  v_max_f32_dpp v32, v32, v32 quad_perm:[1,0,3,2] row_mask:0xf bank_mask:0xf
  s_nop 1
  v_max_f32_dpp v32, v32, v32 quad_perm:[2,3,0,1] row_mask:0xf bank_mask:0xf
  s_nop 1
  v_max_f32_dpp v32, v32, v32 row_half_mirror row_mask:0xf bank_mask:0xf
  s_nop 1
  v_max_f32_dpp v32, v32, v32 row_mirror row_mask:0xf bank_mask:0xf
  v_sub_f32 v30, v28, v32
  v_exp_f32 v30, v30
  s_nop 0
  v_mul_f32 v31, v30, v29
  s_nop 1
  v_add_f32_dpp v31, v31, v31 quad_perm:[1,0,3,2] row_mask:0xf bank_mask:0xf
  s_nop 1
  v_add_f32_dpp v31, v31, v31 quad_perm:[2,3,0,1] row_mask:0xf bank_mask:0xf
  s_nop 1
  v_add_f32_dpp v31, v31, v31 row_half_mirror row_mask:0xf bank_mask:0xf
  s_nop 1
  v_add_f32_dpp v31, v31, v31 row_mirror row_mask:0xf bank_mask:0xf
  v_mul_f32 v31, 0.5, v31
  v_rcp_f32 v31, v31
  v_mov_b32 v34, 0
  v_mov_b32 v35, 0
  v_mov_b32 v36, 0
  v_mov_b32 v37, 0
  v_fmac_f32_dpp v34, v30, v64 row_newbcast:0 row_mask:0xf bank_mask:0xf
  v_fmac_f32_dpp v35, v30, v65 row_newbcast:0 row_mask:0xf bank_mask:0xf
  v_fmac_f32_dpp v36, v30, v66 row_newbcast:1 row_mask:0xf bank_mask:0xf
  v_fmac_f32_dpp v37, v30, v67 row_newbcast:1 row_mask:0xf bank_mask:0xf
  v_fmac_f32_dpp v34, v30, v68 row_newbcast:2 row_mask:0xf bank_mask:0xf
  v_fmac_f32_dpp v35, v30, v69 row_newbcast:2 row_mask:0xf bank_mask:0xf
  v_fmac_f32_dpp v36, v30, v70 row_newbcast:3 row_mask:0xf bank_mask:0xf
  v_fmac_f32_dpp v37, v30, v71 row_newbcast:3 row_mask:0xf bank_mask:0xf
  v_fmac_f32_dpp v34, v30, v72 row_newbcast:4 row_mask:0xf bank_mask:0xf
  v_fmac_f32_dpp v35, v30, v73 row_newbcast:4 row_mask:0xf bank_mask:0xf
  v_fmac_f32_dpp v36, v30, v74 row_newbcast:5 row_mask:0xf bank_mask:0xf
  v_fmac_f32_dpp v37, v30, v75 row_newbcast:5 row_mask:0xf bank_mask:0xf
  v_fmac_f32_dpp v34, v30, v76 row_newbcast:6 row_mask:0xf bank_mask:0xf
  v_fmac_f32_dpp v35, v30, v77 row_newbcast:6 row_mask:0xf bank_mask:0xf
  v_fmac_f32_dpp v36, v30, v78 row_newbcast:7 row_mask:0xf bank_mask:0xf
  v_fmac_f32_dpp v37, v30, v79 row_newbcast:7 row_mask:0xf bank_mask:0xf
  v_pk_add_f32 v[34:35], v[34:35], v[36:37]
  v_pk_mul_f32 v[34:35], v[34:35], v[30:31] op_sel:[0,1] op_sel_hi:[1,1]
  v_cvt_pk_bf16_f32 v34, v34, v35
  ds_write_b32 v16, v34 offset:19968
  s_waitcnt lgkmcnt(0)
  s_barrier
  ds_read_b128 v[96:99], v17 offset:19968
  ds_read_b128 v[100:103], v17 offset:20032
  ds_read_b128 v[104:107], v17 offset:20096
  ds_read_b128 v[108:111], v17 offset:20160
  s_waitcnt lgkmcnt(3)
  v_mfma_f32_16x16x32_bf16 v[224:227], v[96:99], v[172:175], v[224:227]
  v_mfma_f32_16x16x32_bf16 v[228:231], v[96:99], v[188:191], v[228:231]
  s_waitcnt lgkmcnt(2)
  v_mfma_f32_16x16x32_bf16 v[224:227], v[100:103], v[176:179], v[224:227]
  v_mfma_f32_16x16x32_bf16 v[228:231], v[100:103], v[192:195], v[228:231]
  s_waitcnt lgkmcnt(1)
  v_mfma_f32_16x16x32_bf16 v[224:227], v[104:107], v[180:183], v[224:227]
  v_mfma_f32_16x16x32_bf16 v[228:231], v[104:107], v[196:199], v[228:231]
  s_waitcnt lgkmcnt(0)
  v_mfma_f32_16x16x32_bf16 v[224:227], v[108:111], v[184:187], v[224:227]
  v_mfma_f32_16x16x32_bf16 v[228:231], v[108:111], v[200:203], v[228:231]
  s_mov_b64 exec, 0xffff
  s_nop 7
  global_store_dword v18, v224, s[40:41] offset:0 sc1
  global_store_dword v18, v225, s[40:41] offset:512 sc1
  global_store_dword v18, v226, s[40:41] offset:1024 sc1
  global_store_dword v18, v227, s[40:41] offset:1536 sc1
  global_store_dword v18, v228, s[40:41] offset:64 sc1
  global_store_dword v18, v229, s[40:41] offset:576 sc1
  global_store_dword v18, v230, s[40:41] offset:1088 sc1
  global_store_dword v18, v231, s[40:41] offset:1600 sc1
  s_mov_b64 exec, -1
  s_cmp_lt_u32 s43, 4
  s_cbranch_scc0 L_fin_stamp
  s_branch L_final
L_final_pre:
  s_barrier
L_final:
  v_lshrrev_b32 v30, 4, v1
  v_lshlrev_b32 v30, 2, v30
  s_lshl_b32 s76, s42, 4
  v_add_u32 v30, s76, v30
  v_and_b32 v31, 15, v1
  v_lshlrev_b32 v2, 16, v31
  v_lshlrev_b32 v32, 2, v30
  v_add_u32 v2, v2, v32
  s_lshl_b32 s77, s44, 13
  s_lshl_b32 s76, s43, 9
  s_add_u32 s77, s77, s76
  s_add_u32 s77, s77, 1053696
  v_add_u32 v2, s77, v2
  v_add_u32 v3, 1048576, v2
  s_lshl_b32 s78, s44, 7
  v_add_u32 v30, s78, v30
  v_lshlrev_b32 v30, 1, v30
  s_mul_i32 s79, s43, 1280
  v_add_u32 v33, s79, v30
  global_load_dwordx2 v[4:5], v33, s[16:17]
  global_load_dwordx2 v[6:7], v30, s[34:35]
  s_mov_b32 s83, 262144
L_ypoll:
  global_load_dwordx4 v[8:11], v2, s[40:41] sc1
  global_load_dwordx4 v[12:15], v3, s[40:41] sc1
  s_waitcnt vmcnt(0)
  v_max3_u32 v34, v8, v9, v10
  v_max3_u32 v34, v34, v11, v12
  v_max3_u32 v34, v34, v13, v14
  v_max_u32 v34, v34, v15
  v_cmp_eq_u32 vcc, -1, v34
  s_nop 4
  s_cbranch_vccz L_yok
  s_cmp_eq_u32 s83, 0
  s_cbranch_scc1 L_to_28
  s_sub_u32 s83, s83, 1
  s_branch L_ypoll
L_to_28:
L_yok:
  v_add_f32 v8, v8, v12
  v_add_f32 v9, v9, v13
  v_add_f32 v10, v10, v14
  v_add_f32 v11, v11, v15
  s_nop 1
  v_add_f32_dpp v8, v8, v8 quad_perm:[1,0,3,2] row_mask:0xf bank_mask:0xf
  v_add_f32_dpp v9, v9, v9 quad_perm:[1,0,3,2] row_mask:0xf bank_mask:0xf
  v_add_f32_dpp v10, v10, v10 quad_perm:[1,0,3,2] row_mask:0xf bank_mask:0xf
  v_add_f32_dpp v11, v11, v11 quad_perm:[1,0,3,2] row_mask:0xf bank_mask:0xf
  v_add_f32_dpp v8, v8, v8 quad_perm:[2,3,0,1] row_mask:0xf bank_mask:0xf
  v_add_f32_dpp v9, v9, v9 quad_perm:[2,3,0,1] row_mask:0xf bank_mask:0xf
  v_add_f32_dpp v10, v10, v10 quad_perm:[2,3,0,1] row_mask:0xf bank_mask:0xf
  v_add_f32_dpp v11, v11, v11 quad_perm:[2,3,0,1] row_mask:0xf bank_mask:0xf
  v_add_f32_dpp v8, v8, v8 row_half_mirror row_mask:0xf bank_mask:0xf
  v_add_f32_dpp v9, v9, v9 row_half_mirror row_mask:0xf bank_mask:0xf
  v_add_f32_dpp v10, v10, v10 row_half_mirror row_mask:0xf bank_mask:0xf
  v_add_f32_dpp v11, v11, v11 row_half_mirror row_mask:0xf bank_mask:0xf
  v_add_f32_dpp v8, v8, v8 row_mirror row_mask:0xf bank_mask:0xf
  v_add_f32_dpp v9, v9, v9 row_mirror row_mask:0xf bank_mask:0xf
  v_add_f32_dpp v10, v10, v10 row_mirror row_mask:0xf bank_mask:0xf
  v_add_f32_dpp v11, v11, v11 row_mirror row_mask:0xf bank_mask:0xf
  v_lshlrev_b32 v34, 16, v4
  v_and_b32 v35, s46, v4
  v_add_f32 v8, v8, v34
  v_add_f32 v9, v9, v35
  v_lshlrev_b32 v34, 16, v6
  v_and_b32 v35, s46, v6
  v_add_f32 v8, v8, v34
  v_add_f32 v9, v9, v35
  v_lshlrev_b32 v34, 16, v5
  v_and_b32 v35, s46, v5
  v_add_f32 v10, v10, v34
  v_add_f32 v11, v11, v35
  v_lshlrev_b32 v34, 16, v7
  v_and_b32 v35, s46, v7
  v_add_f32 v10, v10, v34
  v_add_f32 v11, v11, v35
  v_cvt_pk_bf16_f32 v12, v8, v9
  v_cvt_pk_bf16_f32 v13, v10, v11
  s_mov_b32 exec_lo, 0x00010001
  s_mov_b32 exec_hi, 0x00010001
  global_store_dwordx2 v33, v[12:13], s[36:37]
  s_mov_b64 exec, -1
L_fin_stamp:
L_end:
  s_endpgm
.section .rodata,"a"
.p2align 6
.amdhsa_kernel parallel_sum__gqa_block_cached__dense_activation_squared_relu__decode_kernel
  .amdhsa_next_free_vgpr 256
  .amdhsa_next_free_sgpr 102
  .amdhsa_accum_offset 256
  .amdhsa_group_segment_fixed_size 0
  .amdhsa_kernarg_size 104
  .amdhsa_user_sgpr_count 2
  .amdhsa_user_sgpr_kernarg_segment_ptr 1
  .amdhsa_system_sgpr_workgroup_id_x 1
.end_amdhsa_kernel
```
